```python
import torch

def _softmax(x, axis=-1):
    return torch.softmax(x, dim=axis)
def _gelu(x):
    return torch.nn.functional.gelu(x, approximate="tanh")
def _silu(x):
    return torch.nn.functional.silu(x)
def _sigmoid(x):
    return torch.sigmoid(x)
def _layernorm(x, axis=-1, eps=1e-5):
    m = x.mean(dim=axis, keepdim=True)
    v = x.var(dim=axis, keepdim=True, unbiased=False)
    return (x - m) / torch.sqrt(v + eps)
def _scatter_add(tgt, idx, src, axis=0):
    return tgt.clone().index_add_(axis, idx, src)
def _segment_sum(src, seg, n):
    out = torch.zeros((n,) + src.shape[1:], dtype=src.dtype)
    return out.index_add_(0, seg, src)
def _pad(x, pw):
    flat = tuple(v for pair in reversed(pw) for v in pair)
    return torch.nn.functional.pad(x, flat)

kernel_name = 'gated_mix__grouped_kv_mqa__dense_activation_silu__prompt'

def setup_inputs():

    _w = (lambda a: (lambda t: t.to(torch.bfloat16) if t.is_floating_point() else t)(torch.as_tensor(a)))
    def _A_setup():
        B, S, D, H = 1, 2048, 512, 32
        Dh = D // H
        return {
            "x": _w((lambda *s: torch.randn(*s, dtype=torch.bfloat16) * 0.05)(B, S, D)),
            "wq": _w((lambda *s: torch.randn(*s, dtype=torch.bfloat16) * 0.8)(D, H * Dh)),
            "wk": _w((lambda *s: torch.randn(*s, dtype=torch.bfloat16) * 0.8)(D, Dh)),
            "wv": _w((lambda *s: torch.randn(*s, dtype=torch.bfloat16) * 0.05)(D, Dh)),
            "wo": _w((lambda *s: torch.randn(*s, dtype=torch.bfloat16) * 0.05)(H * Dh, D)),
        }
    _A_in = _A_setup()

    def _B_setup():
        B, S, D, F = 1, 2048, 512, 1792
        return {
            "x": _w((lambda *s: torch.randn(*s, dtype=torch.bfloat16) * 0.05)(B, S, D)),
            "w1": _w((lambda *s: torch.randn(*s, dtype=torch.bfloat16) * 3.2)(D, F) * (D ** -0.5)),
            "w2": _w((lambda *s: torch.randn(*s, dtype=torch.bfloat16) * 0.1)(F, D) * (F ** -0.5)),
        }
    _B_in = _B_setup()

    return {
        "A_x": _A_in["x"],
        "A_wq": _A_in["wq"],
        "A_wk": _A_in["wk"],
        "A_wv": _A_in["wv"],
        "A_wo": _A_in["wo"],
        "B_x": _B_in["x"],
        "B_w1": _B_in["w1"],
        "B_w2": _B_in["w2"],
        "gate_w": _w((lambda *s: torch.randn(*s, dtype=torch.bfloat16) * 0.05)(512) * 16.0),
    }

def reference(A_x, A_wq, A_wk, A_wv, A_wo, B_x, B_w1, B_w2, gate_w):
    def _A_ref(x, wq, wk, wv, wo):
        B, S, D = x.shape
        H = 32
        Dh = D // H
        q = (lambda x, *d: x.permute(*d))((x @ wq).reshape(B, S, H, Dh), 0, 2, 1, 3)
        k = x @ wk
        v = x @ wv
        scores = torch.einsum("bhqd,bkd->bhqk", q, k) * (Dh ** -0.5)
        p = _softmax(scores, axis=-1)
        o = torch.einsum("bhqk,bkd->bhqd", p, v)
        return (lambda x, *d: x.permute(*d))(o, 0, 2, 1, 3).reshape(B, S, H * Dh) @ wo

    def _B_ref(x, w1, w2):
        h = torch.einsum("bsd,df->bsf", x, w1)
        h = _silu(h)
        out = torch.einsum("bsf,fd->bsd", h, w2)
        return out

    x = A_x
    g = _sigmoid((x * gate_w).sum(-1, keepdims=True))
    a = _A_ref(x, A_wq, A_wk, A_wv, A_wo)
    b = _B_ref(x, B_w1, B_w2)
    return g * a + (1 - g) * b
```

```asm
; @launch grid=(256,1,1) block=(768,1,1) lds=163840
.amdgcn_target "amdgcn-amd-amdhsa--gfx950"
.text
.globl gated_mix__grouped_kv_mqa__dense_activation_silu__prompt_kernel
.p2align 8
.type gated_mix__grouped_kv_mqa__dense_activation_silu__prompt_kernel,@function
gated_mix__grouped_kv_mqa__dense_activation_silu__prompt_kernel:
    s_cmp_ge_u32 s2, 256
    s_cbranch_scc1 L_exit
    s_bfe_u32 s21, s2, 0x20001
    s_lshl_b32 s21, s21, 2
    s_lshr_b32 s22, s2, 6
    s_add_u32 s21, s21, s22
    s_bfe_u32 s22, s2, 0x30003
    s_and_b32 s23, s2, 1
    s_lshl_b32 s23, s23, 3
    s_add_u32 s22, s22, s23
    s_load_dwordx2 s[4:5], s[0:1], 0
    s_mov_b32 s6, 0x200000
    s_mov_b32 s7, 0x00020000
    s_load_dwordx2 s[16:17], s[0:1], 8
    s_mov_b32 s18, 0x80000
    s_mov_b32 s19, 0x00020000
    s_load_dwordx2 s[12:13], s[0:1], 88
    s_mov_b32 s14, 0x1000000
    s_mov_b32 s15, 0x00020000
    s_load_dwordx2 s[60:61], s[0:1], 80
    s_mov_b32 s62, 0x100
    s_mov_b32 s63, 0x00020000
    s_load_dwordx2 s[8:9], s[0:1], 48
    s_mov_b32 s10, 0x1c0000
    s_mov_b32 s11, 0x00020000
    v_lshrrev_b32 v1, 6, v0
    s_nop 0
    v_readfirstlane_b32 s20, v1
    v_and_b32 v0, 63, v0
    s_nop 2
    s_cmp_ge_u32 s20, 8
    s_cbranch_scc1 L_G
    s_cmp_ge_u32 s22, 14
    s_cbranch_scc1 L_A_kv
    s_cmp_lt_u32 s20, 4
    s_cbranch_scc1 L_A_q
    s_sub_u32 s28, s20, 4
    v_lshrrev_b32 v17, 3, v0
    v_lshrrev_b32 v18, 4, v0
    s_lshl_b32 s24, s21, 7
    s_lshl_b32 s25, s28, 5
    s_add_u32 s24, s24, s25
    v_add_u32 v17, s24, v17
    v_lshlrev_b32 v17, 10, v17
    v_and_b32 v19, 7, v0
    v_xor_b32 v19, v19, v18
    v_lshl_add_u32 v12, v19, 4, v17
    v_xor_b32 v13, 64, v12
    v_add_u32 v13, 8192, v13
    s_lshl_b32 s30, s28, 12
    v_lshlrev_b32 v17, 2, v18
    v_and_b32 v19, 15, v0
    v_xor_b32 v17, v17, v19
    v_lshlrev_b32 v17, 4, v17
    s_lshl_b32 s26, s28, 4
    v_add_u32 v16, s26, v18
    v_mul_u32_u24 v16, 3584, v16
    s_lshl_b32 s26, s22, 8
    v_add3_u32 v15, v16, v17, s26
    v_lshrrev_b32 v17, 2, v0
    s_lshl_b32 s31, s28, 10
    s_add_u32 s31, s31, 32768
    s_lshl_b32 s24, s28, 4
    v_add_u32 v17, s24, v17
    v_lshlrev_b32 v17, 10, v17
    v_and_b32 v16, 3, v0
    v_lshl_add_u32 v14, v16, 4, v17
    s_lshl_b32 s24, s22, 6
    v_add_u32 v14, s24, v14
    s_mov_b32 s36, 0
    s_mov_b32 s37, 0
    s_mov_b32 s38, 0
    s_mov_b32 s39, 0
    s_waitcnt lgkmcnt(0)
    s_add_u32 s25, s30, s36
    s_add_u32 m0, s25, 0
    s_add_u32 s24, s37, 0
    buffer_load_dwordx4 v12, s[4:7], s24 offen lds
    s_add_u32 m0, s25, 1024
    s_add_u32 s24, s37, 0
    buffer_load_dwordx4 v13, s[4:7], s24 offen lds
    s_add_u32 m0, s25, 2048
    s_add_u32 s24, s37, 16384
    buffer_load_dwordx4 v12, s[4:7], s24 offen lds
    s_add_u32 m0, s25, 3072
    s_add_u32 s24, s37, 16384
    buffer_load_dwordx4 v13, s[4:7], s24 offen lds
    s_add_u32 m0, s25, 16384
    s_add_u32 s24, s38, 0
    buffer_load_dwordx4 v15, s[8:11], s24 offen lds
    s_add_u32 m0, s25, 17408
    s_add_u32 s24, s38, 14336
    buffer_load_dwordx4 v15, s[8:11], s24 offen lds
    s_add_u32 m0, s25, 18432
    s_add_u32 s24, s38, 28672
    buffer_load_dwordx4 v15, s[8:11], s24 offen lds
    s_add_u32 m0, s25, 19456
    s_add_u32 s24, s38, 43008
    buffer_load_dwordx4 v15, s[8:11], s24 offen lds
    s_add_u32 m0, s31, s36
    s_add_u32 s37, s37, 128
    buffer_load_dwordx4 v14, s[16:19], s39 offen lds
    s_add_u32 s38, s38, 229376
    s_add_u32 s39, s39, 65536
    s_add_u32 s36, s36, 36864
    s_cmp_eq_u32 s36, 147456
    s_cselect_b32 s36, 0, s36
    s_barrier
    s_add_u32 s25, s30, s36
    s_add_u32 m0, s25, 0
    s_add_u32 s24, s37, 0
    buffer_load_dwordx4 v12, s[4:7], s24 offen lds
    s_add_u32 m0, s25, 1024
    s_add_u32 s24, s37, 0
    buffer_load_dwordx4 v13, s[4:7], s24 offen lds
    s_add_u32 m0, s25, 2048
    s_add_u32 s24, s37, 16384
    buffer_load_dwordx4 v12, s[4:7], s24 offen lds
    s_add_u32 m0, s25, 3072
    s_add_u32 s24, s37, 16384
    buffer_load_dwordx4 v13, s[4:7], s24 offen lds
    s_add_u32 m0, s25, 16384
    s_add_u32 s24, s38, 0
    buffer_load_dwordx4 v15, s[8:11], s24 offen lds
    s_add_u32 m0, s25, 17408
    s_add_u32 s24, s38, 14336
    buffer_load_dwordx4 v15, s[8:11], s24 offen lds
    s_add_u32 m0, s25, 18432
    s_add_u32 s24, s38, 28672
    buffer_load_dwordx4 v15, s[8:11], s24 offen lds
    s_add_u32 m0, s25, 19456
    s_add_u32 s24, s38, 43008
    buffer_load_dwordx4 v15, s[8:11], s24 offen lds
    s_add_u32 m0, s31, s36
    s_add_u32 s37, s37, 128
    buffer_load_dwordx4 v14, s[16:19], s39 offen lds
    s_add_u32 s38, s38, 229376
    s_add_u32 s39, s39, 65536
    s_add_u32 s36, s36, 36864
    s_cmp_eq_u32 s36, 147456
    s_cselect_b32 s36, 0, s36
    s_barrier
    s_add_u32 s25, s30, s36
    s_add_u32 m0, s25, 0
    s_add_u32 s24, s37, 0
    buffer_load_dwordx4 v12, s[4:7], s24 offen lds
    s_add_u32 m0, s25, 1024
    s_add_u32 s24, s37, 0
    buffer_load_dwordx4 v13, s[4:7], s24 offen lds
    s_add_u32 m0, s25, 2048
    s_add_u32 s24, s37, 16384
    buffer_load_dwordx4 v12, s[4:7], s24 offen lds
    s_add_u32 m0, s25, 3072
    s_add_u32 s24, s37, 16384
    buffer_load_dwordx4 v13, s[4:7], s24 offen lds
    s_add_u32 m0, s25, 16384
    s_add_u32 s24, s38, 0
    buffer_load_dwordx4 v15, s[8:11], s24 offen lds
    s_add_u32 m0, s25, 17408
    s_add_u32 s24, s38, 14336
    buffer_load_dwordx4 v15, s[8:11], s24 offen lds
    s_add_u32 m0, s25, 18432
    s_add_u32 s24, s38, 28672
    buffer_load_dwordx4 v15, s[8:11], s24 offen lds
    s_add_u32 m0, s25, 19456
    s_add_u32 s24, s38, 43008
    buffer_load_dwordx4 v15, s[8:11], s24 offen lds
    s_add_u32 m0, s31, s36
    s_add_u32 s37, s37, 128
    buffer_load_dwordx4 v14, s[16:19], s39 offen lds
    s_add_u32 s38, s38, 229376
    s_add_u32 s39, s39, 65536
    s_add_u32 s36, s36, 36864
    s_cmp_eq_u32 s36, 147456
    s_cselect_b32 s36, 0, s36
    s_and_b32 s24, s20, 3
    s_lshl_b32 s25, s21, 2
    s_add_u32 s24, s24, s25
    s_lshl_b32 s35, s24, 7
    s_add_u32 s35, s35, 2228224
    s_lshl_b32 s24, s24, 5
    s_lshl_b32 s25, s22, 1
    s_add_u32 s24, s24, s25
    s_lshr_b32 s25, s20, 2
    s_add_u32 s24, s24, s25
    s_lshl_b32 s24, s24, 10
    s_add_u32 s29, s24, 10485760
    v_mov_b32 v20, -1
    v_mov_b32 v21, -1
    v_mov_b32 v22, -1
    v_mov_b32 v23, -1
    v_lshlrev_b32 v24, 4, v0
    buffer_store_dwordx4 v[20:23], v24, s[12:15], s29 offen sc1
    s_mov_b32 s65, 5
.p2align 6
L_p0L:
    s_waitcnt vmcnt(18)
    s_barrier
    s_add_u32 s25, s30, s36
    s_add_u32 m0, s25, 0
    s_add_u32 s24, s37, 0
    buffer_load_dwordx4 v12, s[4:7], s24 offen lds
    s_add_u32 m0, s25, 1024
    s_add_u32 s24, s37, 0
    buffer_load_dwordx4 v13, s[4:7], s24 offen lds
    s_add_u32 m0, s25, 2048
    s_add_u32 s24, s37, 16384
    buffer_load_dwordx4 v12, s[4:7], s24 offen lds
    s_add_u32 m0, s25, 3072
    s_add_u32 s24, s37, 16384
    buffer_load_dwordx4 v13, s[4:7], s24 offen lds
    s_add_u32 m0, s25, 16384
    s_add_u32 s24, s38, 0
    buffer_load_dwordx4 v15, s[8:11], s24 offen lds
    s_add_u32 m0, s25, 17408
    s_add_u32 s24, s38, 14336
    buffer_load_dwordx4 v15, s[8:11], s24 offen lds
    s_add_u32 m0, s25, 18432
    s_add_u32 s24, s38, 28672
    buffer_load_dwordx4 v15, s[8:11], s24 offen lds
    s_add_u32 m0, s25, 19456
    s_add_u32 s24, s38, 43008
    buffer_load_dwordx4 v15, s[8:11], s24 offen lds
    s_add_u32 m0, s31, s36
    s_add_u32 s37, s37, 128
    buffer_load_dwordx4 v14, s[16:19], s39 offen lds
    s_add_u32 s38, s38, 229376
    s_add_u32 s39, s39, 65536
    s_add_u32 s36, s36, 36864
    s_cmp_eq_u32 s36, 147456
    s_cselect_b32 s36, 0, s36
    s_sub_u32 s65, s65, 1
    s_cmp_lg_u32 s65, 0
    s_cbranch_scc1 L_p0L
    s_waitcnt vmcnt(18)
    s_barrier
    s_waitcnt vmcnt(9)
    s_barrier
    s_waitcnt vmcnt(0)
    s_barrier
    s_barrier
    v_lshlrev_b32 v16, 4, v0
    s_lshl_b32 s24, s28, 10
    s_add_u32 s24, s24, 155648
    v_add_u32 v16, s24, v16
    ds_read_b128 v[4:7], v16
    s_branch L_A_main
.p2align 7
L_A_q:
    s_barrier
    s_barrier
    v_and_b32 v16, 31, v0
    v_bfe_u32 v17, v0, 1, 3
    v_lshrrev_b32 v18, 5, v0
    v_xor_b32 v17, v17, v18
    v_lshlrev_b32 v17, 4, v17
    v_lshl_add_u32 v8, v16, 7, v17
    s_lshl_b32 s24, s20, 12
    v_add_u32 v8, s24, v8
    v_xor_b32 v9, 32, v8
    v_xor_b32 v10, 64, v8
    v_xor_b32 v11, 96, v8
    v_bfe_u32 v16, v0, 2, 2
    v_lshl_add_u32 v17, v18, 3, v16
    v_lshlrev_b32 v12, 6, v17
    v_bfe_u32 v17, v0, 4, 1
    v_lshl_add_u32 v12, v17, 5, v12
    v_and_b32 v17, 1, v0
    v_lshl_add_u32 v12, v17, 4, v12
    v_bfe_u32 v17, v0, 1, 1
    v_lshl_add_u32 v12, v17, 3, v12
    v_add_u32 v12, 32768, v12
    v_mov_b32 v72, 0
    v_mov_b32 v73, 0
    v_mov_b32 v74, 0
    v_mov_b32 v75, 0
    v_mov_b32 v76, 0
    v_mov_b32 v77, 0
    v_mov_b32 v78, 0
    v_mov_b32 v79, 0
    v_mov_b32 v80, 0
    v_mov_b32 v81, 0
    v_mov_b32 v82, 0
    v_mov_b32 v83, 0
    v_mov_b32 v84, 0
    v_mov_b32 v85, 0
    v_mov_b32 v86, 0
    v_mov_b32 v87, 0
    v_mov_b32 v16, 163776
    v_mov_b32 v17, 0
    ds_write_b32 v16, v17 offset:0
    ds_write_b32 v16, v17 offset:4
    ds_write_b32 v16, v17 offset:12
    ds_write_b32 v16, v17 offset:16
    s_and_b32 s24, s20, 3
    s_lshl_b32 s25, s21, 2
    s_add_u32 s24, s24, s25
    s_lshl_b32 s35, s24, 7
    s_add_u32 s35, s35, 2228224
    s_lshl_b32 s24, s24, 5
    s_lshl_b32 s25, s22, 1
    s_add_u32 s24, s24, s25
    s_lshr_b32 s25, s20, 2
    s_add_u32 s24, s24, s25
    s_lshl_b32 s24, s24, 10
    s_add_u32 s29, s24, 10485760
    s_mov_b32 s34, 0
    s_mov_b32 s28, 36864
    s_waitcnt lgkmcnt(0)
    v_mov_b32 v20, -1
    v_mov_b32 v21, -1
    v_mov_b32 v22, -1
    v_mov_b32 v23, -1
    v_lshlrev_b32 v24, 4, v0
    buffer_store_dwordx4 v[20:23], v24, s[12:15], s29 offen sc1
    s_setprio 2
    s_mov_b32 s65, 8
.p2align 6
L_p0Q:
    s_barrier
    ds_read_b64_tr_b16 v[40:41], v12 offset:0
    ds_read_b64_tr_b16 v[42:43], v12 offset:256
    ds_read_b128 v[44:47], v8
    ds_read_b64_tr_b16 v[48:49], v12 offset:1024
    ds_read_b64_tr_b16 v[50:51], v12 offset:1280
    ds_read_b128 v[52:55], v9
    ds_read_b64_tr_b16 v[56:57], v12 offset:2048
    ds_read_b64_tr_b16 v[58:59], v12 offset:2304
    ds_read_b128 v[60:63], v10
    ds_read_b64_tr_b16 v[64:65], v12 offset:3072
    ds_read_b64_tr_b16 v[66:67], v12 offset:3328
    ds_read_b128 v[68:71], v11
    s_waitcnt lgkmcnt(9)
    v_mfma_f32_32x32x16_bf16 v[72:87], v[40:43], v[44:47], v[72:87]
    s_waitcnt lgkmcnt(6)
    v_mfma_f32_32x32x16_bf16 v[72:87], v[48:51], v[52:55], v[72:87]
    s_waitcnt lgkmcnt(3)
    v_mfma_f32_32x32x16_bf16 v[72:87], v[56:59], v[60:63], v[72:87]
    s_waitcnt lgkmcnt(0)
    v_mfma_f32_32x32x16_bf16 v[72:87], v[64:67], v[68:71], v[72:87]
    s_add_u32 s34, s34, 1
    s_and_b32 s34, s34, 3
    s_cmp_eq_u32 s34, 0
    s_cselect_b32 s24, 0xfffe5000, s28
    v_add_u32 v8, s24, v8
    v_add_u32 v9, s24, v9
    v_add_u32 v10, s24, v10
    v_add_u32 v11, s24, v11
    v_add_u32 v12, s24, v12
    s_sub_u32 s65, s65, 1
    s_cmp_lg_u32 s65, 0
    s_cbranch_scc1 L_p0Q
    s_mov_b32 s24, 0x3eb8aa3b
    v_mul_f32 v72, s24, v72
    v_mul_f32 v73, s24, v73
    v_mul_f32 v74, s24, v74
    v_mul_f32 v75, s24, v75
    v_mul_f32 v76, s24, v76
    v_mul_f32 v77, s24, v77
    v_mul_f32 v78, s24, v78
    v_mul_f32 v79, s24, v79
    v_mul_f32 v80, s24, v80
    v_mul_f32 v81, s24, v81
    v_mul_f32 v82, s24, v82
    v_mul_f32 v83, s24, v83
    v_mul_f32 v84, s24, v84
    v_mul_f32 v85, s24, v85
    v_mul_f32 v86, s24, v86
    v_mul_f32 v87, s24, v87
    v_cvt_pk_bf16_f32 v4, v72, v73
    v_cvt_pk_bf16_f32 v5, v74, v75
    v_cvt_pk_bf16_f32 v6, v76, v77
    v_cvt_pk_bf16_f32 v7, v78, v79
    v_cvt_pk_bf16_f32 v40, v80, v81
    v_cvt_pk_bf16_f32 v41, v82, v83
    v_cvt_pk_bf16_f32 v42, v84, v85
    v_cvt_pk_bf16_f32 v43, v86, v87
    v_lshlrev_b32 v16, 4, v0
    s_lshl_b32 s24, s20, 10
    s_add_u32 s24, s24, 155648
    v_add_u32 v16, s24, v16
    ds_write_b128 v16, v[40:43]
    s_setprio 0
    s_waitcnt vmcnt(0) lgkmcnt(0)
    s_barrier
    s_branch L_A_main
.p2align 7
L_A_kv:
    s_load_dwordx2 s[48:49], s[0:1], 16
    s_load_dwordx2 s[52:53], s[0:1], 24
    s_load_dwordx2 s[36:37], s[0:1], 64
    s_mov_b32 s38, 0x400
    s_mov_b32 s39, 0x00020000
    s_mov_b32 s50, 16384
    s_mov_b32 s51, 0x00020000
    s_mov_b32 s54, 16384
    s_mov_b32 s55, 0x00020000
    v_lshlrev_b32 v13, 4, v0
    v_lshrrev_b32 v2, 3, v0
    v_lshlrev_b32 v2, 10, v2
    v_bfe_u32 v3, v0, 4, 1
    s_and_b32 s24, s20, 1
    s_lshl_b32 s24, s24, 1
    v_add_u32 v3, s24, v3
    v_lshlrev_b32 v3, 1, v3
    v_and_b32 v4, 7, v0
    v_xor_b32 v3, v3, v4
    v_lshl_add_u32 v14, v3, 4, v2
    v_add_u32 v14, 896, v14
    s_waitcnt lgkmcnt(0)
    s_lshl_b32 s24, s20, 11
    s_add_u32 m0, s24, 129024
    s_add_u32 s25, s24, 0
    buffer_load_dwordx4 v13, s[48:51], s25 offen lds
    s_add_u32 m0, s24, 130048
    s_add_u32 s25, s24, 1024
    buffer_load_dwordx4 v13, s[48:51], s25 offen lds
    s_add_u32 m0, s24, 145536
    s_add_u32 s25, s24, 0
    buffer_load_dwordx4 v13, s[52:55], s25 offen lds
    s_add_u32 m0, s24, 146560
    s_add_u32 s25, s24, 1024
    buffer_load_dwordx4 v13, s[52:55], s25 offen lds
    s_mov_b32 m0, 161920
    s_mov_b32 s25, 0
    buffer_load_dwordx4 v13, s[36:39], s25 offen lds
    s_add_u32 s26, s20, 0
    s_lshl_b32 s25, s26, 10
    s_add_u32 m0, s25, 65536
    s_lshl_b32 s26, s26, 13
    buffer_load_dwordx4 v14, s[16:19], s26 offen lds
    s_add_u32 s26, s20, 8
    s_lshl_b32 s25, s26, 10
    s_add_u32 m0, s25, 65536
    s_lshl_b32 s26, s26, 13
    buffer_load_dwordx4 v14, s[16:19], s26 offen lds
    s_add_u32 s26, s20, 16
    s_lshl_b32 s25, s26, 10
    s_add_u32 m0, s25, 65536
    s_lshl_b32 s26, s26, 13
    buffer_load_dwordx4 v14, s[16:19], s26 offen lds
    s_add_u32 s26, s20, 24
    s_lshl_b32 s25, s26, 10
    s_add_u32 m0, s25, 65536
    s_lshl_b32 s26, s26, 13
    buffer_load_dwordx4 v14, s[16:19], s26 offen lds
    s_add_u32 s26, s20, 32
    s_lshl_b32 s25, s26, 10
    s_add_u32 m0, s25, 65536
    s_lshl_b32 s26, s26, 13
    buffer_load_dwordx4 v14, s[16:19], s26 offen lds
    s_add_u32 s26, s20, 40
    s_lshl_b32 s25, s26, 10
    s_add_u32 m0, s25, 65536
    s_lshl_b32 s26, s26, 13
    buffer_load_dwordx4 v14, s[16:19], s26 offen lds
    s_add_u32 s26, s20, 48
    s_lshl_b32 s25, s26, 10
    s_add_u32 m0, s25, 65536
    s_lshl_b32 s26, s26, 13
    buffer_load_dwordx4 v14, s[16:19], s26 offen lds
    s_add_u32 s26, s20, 56
    s_cmp_ge_u32 s26, 62
    s_cselect_b32 s27, 8, 0
    s_sub_u32 s26, s26, s27
    s_lshl_b32 s25, s26, 10
    s_add_u32 m0, s25, 65536
    s_lshl_b32 s26, s26, 13
    buffer_load_dwordx4 v14, s[16:19], s26 offen lds
    s_and_b32 s24, s20, 1
    s_sub_u32 s25, s22, 14
    s_lshl_b32 s25, s25, 1
    s_add_u32 s24, s24, s25
    s_lshl_b32 s25, s21, 2
    s_add_u32 s24, s24, s25
    s_lshl_b32 s35, s24, 7
    s_add_u32 s35, s35, 2228224
    s_lshl_b32 s24, s24, 5
    s_lshr_b32 s25, s20, 1
    s_add_u32 s24, s24, s25
    s_add_u32 s24, s24, 28
    s_lshl_b32 s24, s24, 10
    s_add_u32 s29, s24, 10485760
    v_mov_b32 v20, -1
    v_mov_b32 v21, -1
    v_mov_b32 v22, -1
    v_mov_b32 v23, -1
    v_lshlrev_b32 v24, 4, v0
    buffer_store_dwordx4 v[20:23], v24, s[12:15], s29 offen sc1
    v_mov_b32 v16, 163776
    v_mov_b32 v17, 0
    ds_write_b32 v16, v17 offset:0
    ds_write_b32 v16, v17 offset:4
    ds_write_b32 v16, v17 offset:12
    ds_write_b32 v16, v17 offset:16
    v_mov_b32 v15, 162944
    ds_write_b32 v15, v17 offset:0
    ds_write_b32 v15, v17 offset:4
    ds_write_b32 v15, v17 offset:8
    ds_write_b32 v15, v17 offset:12
    v_mov_b32 v6, 1
    v_and_b32 v2, 15, v0
    v_lshrrev_b32 v4, 4, v0
    v_xor_b32 v3, v4, v2
    v_lshlrev_b32 v3, 4, v3
    v_lshl_add_u32 v8, v2, 10, v3
    s_and_b32 s24, s20, 1
    s_lshl_b32 s24, s24, 15
    v_add_u32 v8, s24, v8
    v_xor_b32 v9, 64, v8
    v_xor_b32 v10, 128, v8
    v_xor_b32 v11, 192, v8
    v_lshrrev_b32 v3, 2, v2
    v_lshl_add_u32 v5, v4, 3, v3
    v_lshlrev_b32 v12, 7, v5
    v_lshrrev_b32 v3, 1, v3
    v_and_b32 v5, 1, v4
    v_lshl_add_u32 v3, v5, 1, v3
    s_lshr_b32 s24, s20, 1
    v_xor_b32 v3, s24, v3
    v_lshl_add_u32 v12, v3, 5, v12
    v_and_b32 v3, 3, v0
    v_lshl_add_u32 v12, v3, 3, v12
    v_add_u32 v12, 65536, v12
    v_mov_b32 v32, 0
    v_mov_b32 v33, 0
    v_mov_b32 v34, 0
    v_mov_b32 v35, 0
    v_mov_b32 v36, 0
    v_mov_b32 v37, 0
    v_mov_b32 v38, 0
    v_mov_b32 v39, 0
    s_and_b32 s31, s20, 3
    v_and_b32 v2, 15, v0
    v_lshrrev_b32 v4, 4, v0
    v_xor_b32 v3, v4, v2
    v_lshlrev_b32 v3, 4, v3
    v_lshl_add_u32 v90, v2, 10, v3
    s_lshl_b32 s24, s31, 14
    v_add_u32 v90, s24, v90
    v_xor_b32 v91, 64, v90
    v_xor_b32 v92, 128, v90
    v_xor_b32 v93, 192, v90
    v_lshrrev_b32 v3, 2, v2
    v_lshl_add_u32 v3, v4, 3, v3
    v_lshlrev_b32 v94, 5, v3
    v_and_b32 v3, 3, v0
    v_lshl_add_u32 v94, v3, 3, v94
    v_add_u32 v94, 145536, v94
    s_sub_u32 s24, s22, 14
    s_lshl_b32 s24, s24, 2
    s_add_u32 s24, s24, s31
    s_lshl_b32 s25, s21, 3
    s_add_u32 s33, s24, s25
    s_lshr_b32 s25, s33, 1
    s_lshl_b32 s25, s25, 11
    s_add_u32 s30, s25, 2097152
    s_and_b32 s32, s33, 1
    v_and_b32 v5, 1, v4
    v_lshlrev_b32 v95, 8, v5
    v_lshl_add_u32 v95, v2, 4, v95
    v_lshrrev_b32 v3, 1, v4
    v_lshl_add_u32 v95, v3, 3, v95
    s_lshl_b32 s24, s32, 9
    s_add_u32 s24, s24, 1024
    v_add_u32 v95, s24, v95
    v_mov_b32 v120, 0
    v_mov_b32 v121, 0
    v_mov_b32 v122, 0
    v_mov_b32 v123, 0
    s_waitcnt vmcnt(8) lgkmcnt(0)
    s_barrier
    s_cmp_ge_u32 s20, 4
    s_cbranch_scc1 L_kv_nov
    s_mov_b32 s65, 4
    ds_read_b128 v[96:99], v90 offset:0
    ds_read_b64_tr_b16 v[100:101], v94 offset:0
    ds_read_b64_tr_b16 v[102:103], v94 offset:128
    ds_read_b128 v[104:107], v91 offset:0
    ds_read_b64_tr_b16 v[108:109], v94 offset:1024
    ds_read_b64_tr_b16 v[110:111], v94 offset:1152
    ds_read_b128 v[112:115], v92 offset:0
    ds_read_b64_tr_b16 v[116:117], v94 offset:2048
    ds_read_b64_tr_b16 v[118:119], v94 offset:2176
L_kvv:
    s_waitcnt lgkmcnt(6)
    ds_read_b128 v[124:127], v93 offset:0
    ds_read_b64_tr_b16 v[128:129], v94 offset:3072
    ds_read_b64_tr_b16 v[130:131], v94 offset:3200
    v_mfma_f32_16x16x32_bf16 v[120:123], v[96:99], v[100:103], v[120:123]
    s_waitcnt lgkmcnt(6)
    ds_read_b128 v[96:99], v90 offset:256
    ds_read_b64_tr_b16 v[100:101], v94 offset:4096
    ds_read_b64_tr_b16 v[102:103], v94 offset:4224
    v_mfma_f32_16x16x32_bf16 v[120:123], v[104:107], v[108:111], v[120:123]
    s_waitcnt lgkmcnt(6)
    ds_read_b128 v[104:107], v91 offset:256
    ds_read_b64_tr_b16 v[108:109], v94 offset:5120
    ds_read_b64_tr_b16 v[110:111], v94 offset:5248
    v_mfma_f32_16x16x32_bf16 v[120:123], v[112:115], v[116:119], v[120:123]
    s_waitcnt lgkmcnt(6)
    ds_read_b128 v[112:115], v92 offset:256
    ds_read_b64_tr_b16 v[116:117], v94 offset:6144
    ds_read_b64_tr_b16 v[118:119], v94 offset:6272
    v_mfma_f32_16x16x32_bf16 v[120:123], v[124:127], v[128:131], v[120:123]
    v_add_u32 v90, 256, v90
    v_add_u32 v91, 256, v91
    v_add_u32 v92, 256, v92
    v_add_u32 v93, 256, v93
    v_add_u32 v94, 4096, v94
    s_sub_u32 s65, s65, 1
    s_cmp_lg_u32 s65, 0
    s_cbranch_scc1 L_kvv
    s_waitcnt lgkmcnt(0)
    v_cvt_pk_bf16_f32 v96, v120, v121
    v_cvt_pk_bf16_f32 v97, v122, v123
    buffer_store_dwordx2 v[96:97], v95, s[12:15], s30 offen sc1
    s_waitcnt vmcnt(0)
    s_mov_b64 exec, 1
    ds_add_u32 v15, v6 offset:4
    s_mov_b64 exec, -1
    s_mov_b64 exec, 1
    ds_add_rtn_u32 v7, v15, v6
    s_waitcnt lgkmcnt(0)
    v_readfirstlane_b32 s24, v7
    s_mov_b64 exec, -1
    s_nop 2
    s_cmp_eq_u32 s24, 7
    s_cbranch_scc0 L_kv_nosig2
    s_mov_b32 s64, 2097152
L_lp1:
    ds_read_b32 v7, v15 offset:4
    s_waitcnt lgkmcnt(0)
    v_cmp_gt_u32 vcc, 8, v7
    s_nop 4
    s_cbranch_vccz L_lpx2
    s_sub_u32 s64, s64, 1
    s_cmp_eq_u32 s64, 0
    s_cbranch_scc1 L_lpx2
    s_sleep 1
    s_branch L_lp1
L_lpx2:
    s_sub_u32 s24, s22, 14
    s_lshl_b32 s25, s21, 1
    s_add_u32 s24, s24, s25
    s_lshl_b32 s24, s24, 2
    v_mov_b32 v7, 0
    s_mov_b64 exec, 1
    buffer_store_dword v6, v7, s[60:63], s24 offen sc1
    buffer_store_dword v6, v7, s[60:63], s24 offen offset:128 sc1
    s_mov_b64 exec, -1
L_kv_nosig2:
    s_branch L_kv_q
L_kv_nov:
    s_waitcnt vmcnt(0)
    s_mov_b64 exec, 1
    ds_add_u32 v15, v6 offset:4
    s_mov_b64 exec, -1
L_kv_q:
    s_mov_b32 s64, 2097152
L_lp3:
    ds_read_b32 v7, v15 offset:4
    s_waitcnt lgkmcnt(0)
    v_cmp_gt_u32 vcc, 8, v7
    s_nop 4
    s_cbranch_vccz L_lpx4
    s_sub_u32 s64, s64, 1
    s_cmp_eq_u32 s64, 0
    s_cbranch_scc1 L_lpx4
    s_sleep 1
    s_branch L_lp3
L_lpx4:
    ds_read_b64_tr_b16 v[40:41], v12 offset:0
    ds_read_b64_tr_b16 v[42:43], v12 offset:512
    ds_read_b128 v[44:47], v8 offset:0
    ds_read_b128 v[48:51], v8 offset:16384
    ds_read_b64_tr_b16 v[52:53], v12 offset:4096
    ds_read_b64_tr_b16 v[54:55], v12 offset:4608
    ds_read_b128 v[56:59], v9 offset:0
    ds_read_b128 v[60:63], v9 offset:16384
    s_mov_b32 s65, 3
.p2align 6
L_kvq:
    ds_read_b64_tr_b16 v[64:65], v12 offset:8192
    ds_read_b64_tr_b16 v[66:67], v12 offset:8704
    ds_read_b128 v[68:71], v10 offset:0
    ds_read_b128 v[72:75], v10 offset:16384
    s_waitcnt lgkmcnt(8)
    v_mfma_f32_16x16x32_bf16 v[32:35], v[40:43], v[44:47], v[32:35]
    v_mfma_f32_16x16x32_bf16 v[36:39], v[40:43], v[48:51], v[36:39]
    ds_read_b64_tr_b16 v[76:77], v12 offset:12288
    ds_read_b64_tr_b16 v[78:79], v12 offset:12800
    ds_read_b128 v[80:83], v11 offset:0
    ds_read_b128 v[84:87], v11 offset:16384
    s_waitcnt lgkmcnt(8)
    v_mfma_f32_16x16x32_bf16 v[32:35], v[52:55], v[56:59], v[32:35]
    v_mfma_f32_16x16x32_bf16 v[36:39], v[52:55], v[60:63], v[36:39]
    ds_read_b64_tr_b16 v[40:41], v12 offset:16384
    ds_read_b64_tr_b16 v[42:43], v12 offset:16896
    ds_read_b128 v[44:47], v8 offset:256
    ds_read_b128 v[48:51], v8 offset:16640
    s_waitcnt lgkmcnt(8)
    v_mfma_f32_16x16x32_bf16 v[32:35], v[64:67], v[68:71], v[32:35]
    v_mfma_f32_16x16x32_bf16 v[36:39], v[64:67], v[72:75], v[36:39]
    ds_read_b64_tr_b16 v[52:53], v12 offset:20480
    ds_read_b64_tr_b16 v[54:55], v12 offset:20992
    ds_read_b128 v[56:59], v9 offset:256
    ds_read_b128 v[60:63], v9 offset:16640
    s_waitcnt lgkmcnt(8)
    v_mfma_f32_16x16x32_bf16 v[32:35], v[76:79], v[80:83], v[32:35]
    v_mfma_f32_16x16x32_bf16 v[36:39], v[76:79], v[84:87], v[36:39]
    v_add_u32 v8, 256, v8
    v_add_u32 v9, 256, v9
    v_add_u32 v10, 256, v10
    v_add_u32 v11, 256, v11
    v_add_u32 v12, 16384, v12
    s_sub_u32 s65, s65, 1
    s_cmp_lg_u32 s65, 0
    s_cbranch_scc1 L_kvq
    s_mov_b32 s64, 2097152
L_lp5:
    ds_read_b32 v7, v15 offset:8
    s_waitcnt lgkmcnt(0)
    v_cmp_gt_u32 vcc, 4, v7
    s_nop 4
    s_cbranch_vccz L_lpx6
    s_sub_u32 s64, s64, 1
    s_cmp_eq_u32 s64, 0
    s_cbranch_scc1 L_lpx6
    s_sleep 1
    s_branch L_lp5
L_lpx6:
    s_and_b32 s26, s20, 1
    s_add_u32 s26, s26, 62
    s_lshl_b32 s25, s26, 10
    s_add_u32 m0, s25, 65536
    s_lshl_b32 s26, s26, 13
    buffer_load_dwordx4 v14, s[16:19], s26 offen lds
    s_waitcnt vmcnt(0)
    s_mov_b64 exec, 1
    ds_add_u32 v15, v6 offset:12
    s_mov_b64 exec, -1
    s_mov_b32 s64, 2097152
L_lp7:
    ds_read_b32 v7, v15 offset:12
    s_waitcnt lgkmcnt(0)
    v_cmp_gt_u32 vcc, 8, v7
    s_nop 4
    s_cbranch_vccz L_lpx8
    s_sub_u32 s64, s64, 1
    s_cmp_eq_u32 s64, 0
    s_cbranch_scc1 L_lpx8
    s_sleep 1
    s_branch L_lp7
L_lpx8:
    ds_read_b64_tr_b16 v[64:65], v12 offset:8192
    ds_read_b64_tr_b16 v[66:67], v12 offset:8704
    ds_read_b128 v[68:71], v10 offset:0
    ds_read_b128 v[72:75], v10 offset:16384
    s_waitcnt lgkmcnt(8)
    v_mfma_f32_16x16x32_bf16 v[32:35], v[40:43], v[44:47], v[32:35]
    v_mfma_f32_16x16x32_bf16 v[36:39], v[40:43], v[48:51], v[36:39]
    ds_read_b64_tr_b16 v[76:77], v12 offset:12288
    ds_read_b64_tr_b16 v[78:79], v12 offset:12800
    ds_read_b128 v[80:83], v11 offset:0
    ds_read_b128 v[84:87], v11 offset:16384
    s_waitcnt lgkmcnt(8)
    v_mfma_f32_16x16x32_bf16 v[32:35], v[52:55], v[56:59], v[32:35]
    v_mfma_f32_16x16x32_bf16 v[36:39], v[52:55], v[60:63], v[36:39]
    s_waitcnt lgkmcnt(4)
    v_mfma_f32_16x16x32_bf16 v[32:35], v[64:67], v[68:71], v[32:35]
    v_mfma_f32_16x16x32_bf16 v[36:39], v[64:67], v[72:75], v[36:39]
    s_waitcnt lgkmcnt(0)
    v_mfma_f32_16x16x32_bf16 v[32:35], v[76:79], v[80:83], v[32:35]
    v_mfma_f32_16x16x32_bf16 v[36:39], v[76:79], v[84:87], v[36:39]
    s_barrier
    s_nop 7
    s_mov_b32 s24, 0x3eb8aa3b
    v_mul_f32 v32, s24, v32
    v_mul_f32 v33, s24, v33
    v_mul_f32 v34, s24, v34
    v_mul_f32 v35, s24, v35
    v_mul_f32 v36, s24, v36
    v_mul_f32 v37, s24, v37
    v_mul_f32 v38, s24, v38
    v_mul_f32 v39, s24, v39
    v_cvt_pk_bf16_f32 v4, v32, v33
    v_cvt_pk_bf16_f32 v5, v34, v35
    v_cvt_pk_bf16_f32 v6, v36, v37
    v_cvt_pk_bf16_f32 v7, v38, v39
    s_nop 0
    v_permlane16_swap_b32 v4, v6
    v_permlane16_swap_b32 v5, v7
.p2align 7
L_A_main:
    v_mov_b32 v3, 163776
    s_cmp_ge_u32 s20, 4
    s_cbranch_scc1 L_att_noload
    s_cmp_eq_u32 s20, 0
    s_cbranch_scc0 L_kvl_follow
    v_and_b32 v20, 31, v0
    v_lshlrev_b32 v20, 2, v20
    s_and_b32 s65, s2, 1
    s_lshl_b32 s65, s65, 7
    v_add_u32 v20, s65, v20
    s_mov_b32 s64, 524288
L_poll9:
    buffer_load_dword v21, v20, s[60:63], 0 offen sc1
    s_waitcnt vmcnt(0)
    v_cmp_ne_u32 vcc, 1, v21
    s_nop 4
    s_cbranch_vccz L_pollx10
    s_sub_u32 s64, s64, 1
    s_cmp_eq_u32 s64, 0
    s_cbranch_scc1 L_pollx10
    s_sleep 6
    s_branch L_poll9
L_pollx10:
    v_mov_b32 v22, 1
    s_mov_b64 exec, 1
    ds_add_u32 v3, v22 offset:12
    s_mov_b64 exec, -1
    s_branch L_kvl_go
L_kvl_follow:
    s_mov_b32 s64, 2097152
L_lp11:
    ds_read_b32 v21, v3 offset:12
    s_waitcnt lgkmcnt(0)
    v_cmp_gt_u32 vcc, 1, v21
    s_nop 4
    s_cbranch_vccz L_lpx12
    s_sub_u32 s64, s64, 1
    s_cmp_eq_u32 s64, 0
    s_cbranch_scc1 L_lpx12
    s_sleep 1
    s_branch L_lp11
L_lpx12:
    v_mov_b32 v22, 1
L_kvl_go:
    v_lshlrev_b32 v20, 4, v0
    s_lshl_b32 s24, s20, 10
    s_add_u32 s25, s24, 2097152
    s_add_u32 m0, s24, 0
    s_add_u32 s26, s25, 0
    buffer_load_dwordx4 v20, s[12:15], s26 offen sc1 lds
    s_add_u32 m0, s24, 4096
    s_add_u32 s26, s25, 4096
    buffer_load_dwordx4 v20, s[12:15], s26 offen sc1 lds
    s_add_u32 m0, s24, 8192
    s_add_u32 s26, s25, 8192
    buffer_load_dwordx4 v20, s[12:15], s26 offen sc1 lds
    s_add_u32 m0, s24, 12288
    s_add_u32 s26, s25, 12288
    buffer_load_dwordx4 v20, s[12:15], s26 offen sc1 lds
    s_add_u32 m0, s24, 16384
    s_add_u32 s26, s25, 16384
    buffer_load_dwordx4 v20, s[12:15], s26 offen sc1 lds
    s_add_u32 m0, s24, 20480
    s_add_u32 s26, s25, 20480
    buffer_load_dwordx4 v20, s[12:15], s26 offen sc1 lds
    s_add_u32 m0, s24, 24576
    s_add_u32 s26, s25, 24576
    buffer_load_dwordx4 v20, s[12:15], s26 offen sc1 lds
    s_add_u32 m0, s24, 28672
    s_add_u32 s26, s25, 28672
    buffer_load_dwordx4 v20, s[12:15], s26 offen sc1 lds
    s_add_u32 m0, s24, 32768
    s_add_u32 s26, s25, 32768
    buffer_load_dwordx4 v20, s[12:15], s26 offen sc1 lds
    s_add_u32 m0, s24, 36864
    s_add_u32 s26, s25, 36864
    buffer_load_dwordx4 v20, s[12:15], s26 offen sc1 lds
    s_add_u32 m0, s24, 40960
    s_add_u32 s26, s25, 40960
    buffer_load_dwordx4 v20, s[12:15], s26 offen sc1 lds
    s_add_u32 m0, s24, 45056
    s_add_u32 s26, s25, 45056
    buffer_load_dwordx4 v20, s[12:15], s26 offen sc1 lds
    s_waitcnt vmcnt(6)
    s_mov_b64 exec, 1
    ds_add_u32 v3, v22 offset:0
    s_mov_b64 exec, -1
    s_add_u32 m0, s24, 49152
    s_add_u32 s26, s25, 49152
    buffer_load_dwordx4 v20, s[12:15], s26 offen sc1 lds
    s_add_u32 m0, s24, 53248
    s_add_u32 s26, s25, 53248
    buffer_load_dwordx4 v20, s[12:15], s26 offen sc1 lds
    s_add_u32 m0, s24, 57344
    s_add_u32 s26, s25, 57344
    buffer_load_dwordx4 v20, s[12:15], s26 offen sc1 lds
    s_add_u32 m0, s24, 61440
    s_add_u32 s26, s25, 61440
    buffer_load_dwordx4 v20, s[12:15], s26 offen sc1 lds
    s_add_u32 m0, s24, 65536
    s_add_u32 s26, s25, 65536
    buffer_load_dwordx4 v20, s[12:15], s26 offen sc1 lds
    s_add_u32 m0, s24, 69632
    s_add_u32 s26, s25, 69632
    buffer_load_dwordx4 v20, s[12:15], s26 offen sc1 lds
    s_add_u32 m0, s24, 73728
    s_add_u32 s26, s25, 73728
    buffer_load_dwordx4 v20, s[12:15], s26 offen sc1 lds
    s_add_u32 m0, s24, 77824
    s_add_u32 s26, s25, 77824
    buffer_load_dwordx4 v20, s[12:15], s26 offen sc1 lds
    s_add_u32 m0, s24, 81920
    s_add_u32 s26, s25, 81920
    buffer_load_dwordx4 v20, s[12:15], s26 offen sc1 lds
    s_add_u32 m0, s24, 86016
    s_add_u32 s26, s25, 86016
    buffer_load_dwordx4 v20, s[12:15], s26 offen sc1 lds
    s_add_u32 m0, s24, 90112
    s_add_u32 s26, s25, 90112
    buffer_load_dwordx4 v20, s[12:15], s26 offen sc1 lds
    s_add_u32 m0, s24, 94208
    s_add_u32 s26, s25, 94208
    buffer_load_dwordx4 v20, s[12:15], s26 offen sc1 lds
    s_add_u32 m0, s24, 98304
    s_add_u32 s26, s25, 98304
    buffer_load_dwordx4 v20, s[12:15], s26 offen sc1 lds
    s_add_u32 m0, s24, 102400
    s_add_u32 s26, s25, 102400
    buffer_load_dwordx4 v20, s[12:15], s26 offen sc1 lds
    s_add_u32 m0, s24, 106496
    s_add_u32 s26, s25, 106496
    buffer_load_dwordx4 v20, s[12:15], s26 offen sc1 lds
    s_add_u32 m0, s24, 110592
    s_add_u32 s26, s25, 110592
    buffer_load_dwordx4 v20, s[12:15], s26 offen sc1 lds
    s_add_u32 m0, s24, 114688
    s_add_u32 s26, s25, 114688
    buffer_load_dwordx4 v20, s[12:15], s26 offen sc1 lds
    s_add_u32 m0, s24, 118784
    s_add_u32 s26, s25, 118784
    buffer_load_dwordx4 v20, s[12:15], s26 offen sc1 lds
    s_add_u32 m0, s24, 122880
    s_add_u32 s26, s25, 122880
    buffer_load_dwordx4 v20, s[12:15], s26 offen sc1 lds
    s_add_u32 m0, s24, 126976
    s_add_u32 s26, s25, 126976
    buffer_load_dwordx4 v20, s[12:15], s26 offen sc1 lds
    s_waitcnt vmcnt(0)
    s_mov_b64 exec, 1
    ds_add_u32 v3, v22 offset:4
    s_mov_b64 exec, -1
.p2align 7
L_att_noload:
    v_lshlrev_b32 v8, 4, v0
    v_and_b32 v116, 15, v0
    v_lshlrev_b32 v116, 4, v116
    v_lshrrev_b32 v117, 5, v0
    v_lshl_add_u32 v9, v117, 8, v116
    s_mov_b32 s40, 0x0000ffff
    s_mov_b32 s41, 0x0000ffff
    v_and_b32 v116, 27, v0
    v_cmp_eq_u32 vcc, 16, v116
    v_mov_b32 v117, 0x3f803f80
    s_nop 0
    v_cndmask_b32 v116, 0, v117, vcc
    v_mov_b32 v20, v116
    v_mov_b32 v21, v116
    v_mov_b32 v22, v116
    v_mov_b32 v23, v116
    v_mov_b32 v24, v116
    v_mov_b32 v25, v116
    v_mov_b32 v26, v116
    v_mov_b32 v27, v116
    v_mov_b32 v28, v116
    v_mov_b32 v29, v116
    v_mov_b32 v30, v116
    v_mov_b32 v31, v116
    v_mov_b32 v32, v116
    v_mov_b32 v33, v116
    v_mov_b32 v34, v116
    v_mov_b32 v35, v116
    v_and_b32 v2, 31, v0
    v_lshlrev_b32 v2, 2, v2
    v_mov_b32 v100, 0
    v_mov_b32 v101, 0
    v_mov_b32 v102, 0
    v_mov_b32 v103, 0
    v_mov_b32 v104, 0
    v_mov_b32 v105, 0
    v_mov_b32 v106, 0
    v_mov_b32 v107, 0
    v_mov_b32 v108, 0
    v_mov_b32 v109, 0
    v_mov_b32 v110, 0
    v_mov_b32 v111, 0
    v_mov_b32 v112, 0
    v_mov_b32 v113, 0
    v_mov_b32 v114, 0
    v_mov_b32 v115, 0
    s_mov_b32 s43, 0
    v_mov_b32 v84, 0
    v_mov_b32 v85, 0
    v_mov_b32 v86, 0
    v_mov_b32 v87, 0
    v_mov_b32 v88, 0
    v_mov_b32 v89, 0
    v_mov_b32 v90, 0
    v_mov_b32 v91, 0
    v_mov_b32 v92, 0
    v_mov_b32 v93, 0
    v_mov_b32 v94, 0
    v_mov_b32 v95, 0
    v_mov_b32 v96, 0
    v_mov_b32 v97, 0
    v_mov_b32 v98, 0
    v_mov_b32 v99, 0
    v_mov_b32 v76, 0
    v_mov_b32 v77, 0
    v_mov_b32 v78, 0
    v_mov_b32 v79, 0
    v_mov_b32 v80, 0
    v_mov_b32 v81, 0
    v_mov_b32 v82, 0
    v_mov_b32 v83, 0
    v_mov_b32 v66, 0
    v_mov_b32 v67, 0
    s_mov_b32 s64, 2097152
L_lp13:
    ds_read_b32 v133, v3 offset:0
    s_waitcnt lgkmcnt(0)
    v_cmp_gt_u32 vcc, 4, v133
    s_nop 4
    s_cbranch_vccz L_lpx14
    s_sub_u32 s64, s64, 1
    s_cmp_eq_u32 s64, 0
    s_cbranch_scc1 L_lpx14
    s_sleep 1
    s_branch L_lp13
L_lpx14:
    buffer_load_dword v132, v2, s[12:15], s35 offen sc1
    s_cmp_lt_u32 s20, 4
    s_cbranch_scc1 L_att_old
    s_setprio 2
    s_branch L_att_go
L_att_old:
    s_setprio 1
L_att_go:
L_att_pass:
    ds_read_b128 v[12:15], v8 offset:0
    ds_read_b128 v[16:19], v8 offset:2048
    s_mov_b64 exec, s[40:41]
    ds_read_b128 v[20:23], v9 offset:1024
    ds_read_b128 v[24:27], v9 offset:1536
    s_mov_b64 exec, -1
    s_waitcnt lgkmcnt(3)
    v_mfma_f32_32x32x16_bf16 v[36:51], v[12:15], v[4:7], v[100:115]
    ds_read_b128 v[12:15], v8 offset:4096
    s_nop 7
    s_nop 1
    s_mov_b32 s42, 6
.p2align 6
L_att_loopA:
    v_exp_f32 v36, v36
    v_exp_f32 v37, v37
    v_cvt_pk_bf16_f32 v83, v66, v67
    v_exp_f32 v38, v38
    v_exp_f32 v39, v39
    v_cvt_pk_bf16_f32 v68, v36, v37
    s_waitcnt lgkmcnt(3)
    v_mfma_f32_32x32x16_bf16 v[52:67], v[16:19], v[4:7], v[100:115]
    ds_read_b128 v[16:19], v8 offset:6144
    v_exp_f32 v40, v40
    v_exp_f32 v41, v41
    v_cvt_pk_bf16_f32 v69, v38, v39
    v_exp_f32 v42, v42
    v_exp_f32 v43, v43
    v_cvt_pk_bf16_f32 v70, v40, v41
    v_mfma_f32_32x32x16_bf16 v[84:99], v[28:31], v[76:79], v[84:99]
    v_exp_f32 v44, v44
    v_exp_f32 v45, v45
    v_cvt_pk_bf16_f32 v71, v42, v43
    v_exp_f32 v46, v46
    v_exp_f32 v47, v47
    v_cvt_pk_bf16_f32 v72, v44, v45
    v_exp_f32 v48, v48
    v_exp_f32 v49, v49
    v_cvt_pk_bf16_f32 v73, v46, v47
    v_mfma_f32_32x32x16_bf16 v[84:99], v[32:35], v[80:83], v[84:99]
    s_mov_b64 exec, s[40:41]
    ds_read_b128 v[28:31], v9 offset:3072
    ds_read_b128 v[32:35], v9 offset:3584
    s_mov_b64 exec, -1
    v_exp_f32 v50, v50
    v_exp_f32 v51, v51
    v_cvt_pk_bf16_f32 v74, v48, v49
    v_exp_f32 v52, v52
    v_exp_f32 v53, v53
    v_cvt_pk_bf16_f32 v75, v50, v51
    v_exp_f32 v54, v54
    v_exp_f32 v55, v55
    v_cvt_pk_bf16_f32 v76, v52, v53
    s_waitcnt lgkmcnt(3)
    v_mfma_f32_32x32x16_bf16 v[36:51], v[12:15], v[4:7], v[100:115]
    ds_read_b128 v[12:15], v8 offset:8192
    v_exp_f32 v56, v56
    v_exp_f32 v57, v57
    v_cvt_pk_bf16_f32 v77, v54, v55
    v_exp_f32 v58, v58
    v_exp_f32 v59, v59
    v_cvt_pk_bf16_f32 v78, v56, v57
    v_mfma_f32_32x32x16_bf16 v[84:99], v[20:23], v[68:71], v[84:99]
    v_exp_f32 v60, v60
    v_exp_f32 v61, v61
    v_cvt_pk_bf16_f32 v79, v58, v59
    v_exp_f32 v62, v62
    v_exp_f32 v63, v63
    v_cvt_pk_bf16_f32 v80, v60, v61
    v_exp_f32 v64, v64
    v_exp_f32 v65, v65
    v_cvt_pk_bf16_f32 v81, v62, v63
    v_mfma_f32_32x32x16_bf16 v[84:99], v[24:27], v[72:75], v[84:99]
    s_mov_b64 exec, s[40:41]
    ds_read_b128 v[20:23], v9 offset:5120
    ds_read_b128 v[24:27], v9 offset:5632
    s_mov_b64 exec, -1
    v_exp_f32 v66, v66
    v_exp_f32 v67, v67
    v_cvt_pk_bf16_f32 v82, v64, v65
    v_exp_f32 v36, v36
    v_exp_f32 v37, v37
    v_cvt_pk_bf16_f32 v83, v66, v67
    v_exp_f32 v38, v38
    v_exp_f32 v39, v39
    v_cvt_pk_bf16_f32 v68, v36, v37
    s_waitcnt lgkmcnt(3)
    v_mfma_f32_32x32x16_bf16 v[52:67], v[16:19], v[4:7], v[100:115]
    ds_read_b128 v[16:19], v8 offset:10240
    v_exp_f32 v40, v40
    v_exp_f32 v41, v41
    v_cvt_pk_bf16_f32 v69, v38, v39
    v_exp_f32 v42, v42
    v_exp_f32 v43, v43
    v_cvt_pk_bf16_f32 v70, v40, v41
    v_mfma_f32_32x32x16_bf16 v[84:99], v[28:31], v[76:79], v[84:99]
    v_exp_f32 v44, v44
    v_exp_f32 v45, v45
    v_cvt_pk_bf16_f32 v71, v42, v43
    v_exp_f32 v46, v46
    v_exp_f32 v47, v47
    v_cvt_pk_bf16_f32 v72, v44, v45
    v_exp_f32 v48, v48
    v_exp_f32 v49, v49
    v_cvt_pk_bf16_f32 v73, v46, v47
    v_mfma_f32_32x32x16_bf16 v[84:99], v[32:35], v[80:83], v[84:99]
    s_mov_b64 exec, s[40:41]
    ds_read_b128 v[28:31], v9 offset:7168
    ds_read_b128 v[32:35], v9 offset:7680
    s_mov_b64 exec, -1
    v_exp_f32 v50, v50
    v_exp_f32 v51, v51
    v_cvt_pk_bf16_f32 v74, v48, v49
    v_exp_f32 v52, v52
    v_exp_f32 v53, v53
    v_cvt_pk_bf16_f32 v75, v50, v51
    v_exp_f32 v54, v54
    v_exp_f32 v55, v55
    v_cvt_pk_bf16_f32 v76, v52, v53
    s_waitcnt lgkmcnt(3)
    v_mfma_f32_32x32x16_bf16 v[36:51], v[12:15], v[4:7], v[100:115]
    ds_read_b128 v[12:15], v8 offset:12288
    v_exp_f32 v56, v56
    v_exp_f32 v57, v57
    v_cvt_pk_bf16_f32 v77, v54, v55
    v_exp_f32 v58, v58
    v_exp_f32 v59, v59
    v_cvt_pk_bf16_f32 v78, v56, v57
    v_mfma_f32_32x32x16_bf16 v[84:99], v[20:23], v[68:71], v[84:99]
    v_exp_f32 v60, v60
    v_exp_f32 v61, v61
    v_cvt_pk_bf16_f32 v79, v58, v59
    v_exp_f32 v62, v62
    v_exp_f32 v63, v63
    v_cvt_pk_bf16_f32 v80, v60, v61
    v_exp_f32 v64, v64
    v_exp_f32 v65, v65
    v_cvt_pk_bf16_f32 v81, v62, v63
    v_mfma_f32_32x32x16_bf16 v[84:99], v[24:27], v[72:75], v[84:99]
    s_mov_b64 exec, s[40:41]
    ds_read_b128 v[20:23], v9 offset:9216
    ds_read_b128 v[24:27], v9 offset:9728
    s_mov_b64 exec, -1
    v_exp_f32 v66, v66
    v_exp_f32 v67, v67
    v_cvt_pk_bf16_f32 v82, v64, v65
    v_exp_f32 v36, v36
    v_exp_f32 v37, v37
    v_cvt_pk_bf16_f32 v83, v66, v67
    v_exp_f32 v38, v38
    v_exp_f32 v39, v39
    v_cvt_pk_bf16_f32 v68, v36, v37
    s_waitcnt lgkmcnt(3)
    v_mfma_f32_32x32x16_bf16 v[52:67], v[16:19], v[4:7], v[100:115]
    ds_read_b128 v[16:19], v8 offset:14336
    v_exp_f32 v40, v40
    v_exp_f32 v41, v41
    v_cvt_pk_bf16_f32 v69, v38, v39
    v_exp_f32 v42, v42
    v_exp_f32 v43, v43
    v_cvt_pk_bf16_f32 v70, v40, v41
    v_mfma_f32_32x32x16_bf16 v[84:99], v[28:31], v[76:79], v[84:99]
    v_exp_f32 v44, v44
    v_exp_f32 v45, v45
    v_cvt_pk_bf16_f32 v71, v42, v43
    v_exp_f32 v46, v46
    v_exp_f32 v47, v47
    v_cvt_pk_bf16_f32 v72, v44, v45
    v_exp_f32 v48, v48
    v_exp_f32 v49, v49
    v_cvt_pk_bf16_f32 v73, v46, v47
    v_mfma_f32_32x32x16_bf16 v[84:99], v[32:35], v[80:83], v[84:99]
    s_mov_b64 exec, s[40:41]
    ds_read_b128 v[28:31], v9 offset:11264
    ds_read_b128 v[32:35], v9 offset:11776
    s_mov_b64 exec, -1
    v_exp_f32 v50, v50
    v_exp_f32 v51, v51
    v_cvt_pk_bf16_f32 v74, v48, v49
    v_exp_f32 v52, v52
    v_exp_f32 v53, v53
    v_cvt_pk_bf16_f32 v75, v50, v51
    v_exp_f32 v54, v54
    v_exp_f32 v55, v55
    v_cvt_pk_bf16_f32 v76, v52, v53
    s_waitcnt lgkmcnt(3)
    v_mfma_f32_32x32x16_bf16 v[36:51], v[12:15], v[4:7], v[100:115]
    ds_read_b128 v[12:15], v8 offset:16384
    v_exp_f32 v56, v56
    v_exp_f32 v57, v57
    v_cvt_pk_bf16_f32 v77, v54, v55
    v_exp_f32 v58, v58
    v_exp_f32 v59, v59
    v_cvt_pk_bf16_f32 v78, v56, v57
    v_mfma_f32_32x32x16_bf16 v[84:99], v[20:23], v[68:71], v[84:99]
    v_exp_f32 v60, v60
    v_exp_f32 v61, v61
    v_cvt_pk_bf16_f32 v79, v58, v59
    v_exp_f32 v62, v62
    v_exp_f32 v63, v63
    v_cvt_pk_bf16_f32 v80, v60, v61
    v_exp_f32 v64, v64
    v_exp_f32 v65, v65
    v_cvt_pk_bf16_f32 v81, v62, v63
    v_mfma_f32_32x32x16_bf16 v[84:99], v[24:27], v[72:75], v[84:99]
    s_mov_b64 exec, s[40:41]
    ds_read_b128 v[20:23], v9 offset:13312
    ds_read_b128 v[24:27], v9 offset:13824
    s_mov_b64 exec, -1
    v_exp_f32 v66, v66
    v_exp_f32 v67, v67
    v_cvt_pk_bf16_f32 v82, v64, v65
    v_exp_f32 v36, v36
    v_exp_f32 v37, v37
    v_cvt_pk_bf16_f32 v83, v66, v67
    v_exp_f32 v38, v38
    v_exp_f32 v39, v39
    v_cvt_pk_bf16_f32 v68, v36, v37
    s_waitcnt lgkmcnt(3)
    v_mfma_f32_32x32x16_bf16 v[52:67], v[16:19], v[4:7], v[100:115]
    ds_read_b128 v[16:19], v8 offset:18432
    v_exp_f32 v40, v40
    v_exp_f32 v41, v41
    v_cvt_pk_bf16_f32 v69, v38, v39
    v_exp_f32 v42, v42
    v_exp_f32 v43, v43
    v_cvt_pk_bf16_f32 v70, v40, v41
    v_mfma_f32_32x32x16_bf16 v[84:99], v[28:31], v[76:79], v[84:99]
    v_exp_f32 v44, v44
    v_exp_f32 v45, v45
    v_cvt_pk_bf16_f32 v71, v42, v43
    v_exp_f32 v46, v46
    v_exp_f32 v47, v47
    v_cvt_pk_bf16_f32 v72, v44, v45
    v_exp_f32 v48, v48
    v_exp_f32 v49, v49
    v_cvt_pk_bf16_f32 v73, v46, v47
    v_mfma_f32_32x32x16_bf16 v[84:99], v[32:35], v[80:83], v[84:99]
    s_mov_b64 exec, s[40:41]
    ds_read_b128 v[28:31], v9 offset:15360
    ds_read_b128 v[32:35], v9 offset:15872
    s_mov_b64 exec, -1
    v_exp_f32 v50, v50
    v_exp_f32 v51, v51
    v_cvt_pk_bf16_f32 v74, v48, v49
    v_exp_f32 v52, v52
    v_exp_f32 v53, v53
    v_cvt_pk_bf16_f32 v75, v50, v51
    v_exp_f32 v54, v54
    v_exp_f32 v55, v55
    v_cvt_pk_bf16_f32 v76, v52, v53
    s_waitcnt lgkmcnt(3)
    v_mfma_f32_32x32x16_bf16 v[36:51], v[12:15], v[4:7], v[100:115]
    ds_read_b128 v[12:15], v8 offset:20480
    v_exp_f32 v56, v56
    v_exp_f32 v57, v57
    v_cvt_pk_bf16_f32 v77, v54, v55
    v_exp_f32 v58, v58
    v_exp_f32 v59, v59
    v_cvt_pk_bf16_f32 v78, v56, v57
    v_mfma_f32_32x32x16_bf16 v[84:99], v[20:23], v[68:71], v[84:99]
    v_exp_f32 v60, v60
    v_exp_f32 v61, v61
    v_cvt_pk_bf16_f32 v79, v58, v59
    v_exp_f32 v62, v62
    v_exp_f32 v63, v63
    v_cvt_pk_bf16_f32 v80, v60, v61
    v_exp_f32 v64, v64
    v_exp_f32 v65, v65
    v_cvt_pk_bf16_f32 v81, v62, v63
    v_mfma_f32_32x32x16_bf16 v[84:99], v[24:27], v[72:75], v[84:99]
    s_mov_b64 exec, s[40:41]
    ds_read_b128 v[20:23], v9 offset:17408
    ds_read_b128 v[24:27], v9 offset:17920
    s_mov_b64 exec, -1
    v_exp_f32 v66, v66
    v_exp_f32 v67, v67
    v_cvt_pk_bf16_f32 v82, v64, v65
    v_add_u32 v8, 16384, v8
    v_add_u32 v9, 16384, v9
    s_cmp_eq_u32 s42, 6
    s_cbranch_scc1 L_att_landed
L_att_landed_ret:
    s_sub_u32 s42, s42, 1
    s_cmp_lg_u32 s42, 0
    s_cbranch_scc1 L_att_loopA
    s_mov_b32 s42, 2
.p2align 6
L_att_loopB:
    v_exp_f32 v36, v36
    v_exp_f32 v37, v37
    v_cvt_pk_bf16_f32 v83, v66, v67
    v_exp_f32 v38, v38
    v_exp_f32 v39, v39
    v_cvt_pk_bf16_f32 v68, v36, v37
    s_waitcnt lgkmcnt(3)
    v_mfma_f32_32x32x16_bf16 v[52:67], v[16:19], v[4:7], v[100:115]
    ds_read_b128 v[16:19], v8 offset:6144
    v_exp_f32 v40, v40
    v_exp_f32 v41, v41
    v_cvt_pk_bf16_f32 v69, v38, v39
    v_exp_f32 v42, v42
    v_exp_f32 v43, v43
    v_cvt_pk_bf16_f32 v70, v40, v41
    v_mfma_f32_32x32x16_bf16 v[84:99], v[28:31], v[76:79], v[84:99]
    v_exp_f32 v44, v44
    v_exp_f32 v45, v45
    v_cvt_pk_bf16_f32 v71, v42, v43
    v_exp_f32 v46, v46
    v_exp_f32 v47, v47
    v_cvt_pk_bf16_f32 v72, v44, v45
    v_exp_f32 v48, v48
    v_exp_f32 v49, v49
    v_cvt_pk_bf16_f32 v73, v46, v47
    v_mfma_f32_32x32x16_bf16 v[84:99], v[32:35], v[80:83], v[84:99]
    s_mov_b64 exec, s[40:41]
    ds_read_b128 v[28:31], v9 offset:3072
    ds_read_b128 v[32:35], v9 offset:3584
    s_mov_b64 exec, -1
    v_exp_f32 v50, v50
    v_exp_f32 v51, v51
    v_cvt_pk_bf16_f32 v74, v48, v49
    s_setprio 1
    v_exp_f32 v52, v52
    v_exp_f32 v53, v53
    v_cvt_pk_bf16_f32 v75, v50, v51
    v_exp_f32 v54, v54
    v_exp_f32 v55, v55
    v_cvt_pk_bf16_f32 v76, v52, v53
    s_waitcnt lgkmcnt(3)
    v_mfma_f32_32x32x16_bf16 v[36:51], v[12:15], v[4:7], v[100:115]
    ds_read_b128 v[12:15], v8 offset:8192
    v_exp_f32 v56, v56
    v_exp_f32 v57, v57
    v_cvt_pk_bf16_f32 v77, v54, v55
    v_exp_f32 v58, v58
    v_exp_f32 v59, v59
    v_cvt_pk_bf16_f32 v78, v56, v57
    v_mfma_f32_32x32x16_bf16 v[84:99], v[20:23], v[68:71], v[84:99]
    v_exp_f32 v60, v60
    v_exp_f32 v61, v61
    v_cvt_pk_bf16_f32 v79, v58, v59
    v_exp_f32 v62, v62
    v_exp_f32 v63, v63
    v_cvt_pk_bf16_f32 v80, v60, v61
    v_exp_f32 v64, v64
    v_exp_f32 v65, v65
    v_cvt_pk_bf16_f32 v81, v62, v63
    v_mfma_f32_32x32x16_bf16 v[84:99], v[24:27], v[72:75], v[84:99]
    s_mov_b64 exec, s[40:41]
    ds_read_b128 v[20:23], v9 offset:5120
    ds_read_b128 v[24:27], v9 offset:5632
    s_mov_b64 exec, -1
    v_exp_f32 v66, v66
    v_exp_f32 v67, v67
    v_cvt_pk_bf16_f32 v82, v64, v65
    v_exp_f32 v36, v36
    v_exp_f32 v37, v37
    v_cvt_pk_bf16_f32 v83, v66, v67
    v_exp_f32 v38, v38
    v_exp_f32 v39, v39
    v_cvt_pk_bf16_f32 v68, v36, v37
    s_waitcnt lgkmcnt(3)
    v_mfma_f32_32x32x16_bf16 v[52:67], v[16:19], v[4:7], v[100:115]
    ds_read_b128 v[16:19], v8 offset:10240
    v_exp_f32 v40, v40
    v_exp_f32 v41, v41
    v_cvt_pk_bf16_f32 v69, v38, v39
    v_exp_f32 v42, v42
    v_exp_f32 v43, v43
    v_cvt_pk_bf16_f32 v70, v40, v41
    v_mfma_f32_32x32x16_bf16 v[84:99], v[28:31], v[76:79], v[84:99]
    v_exp_f32 v44, v44
    v_exp_f32 v45, v45
    v_cvt_pk_bf16_f32 v71, v42, v43
    v_exp_f32 v46, v46
    v_exp_f32 v47, v47
    v_cvt_pk_bf16_f32 v72, v44, v45
    v_exp_f32 v48, v48
    v_exp_f32 v49, v49
    v_cvt_pk_bf16_f32 v73, v46, v47
    v_mfma_f32_32x32x16_bf16 v[84:99], v[32:35], v[80:83], v[84:99]
    s_mov_b64 exec, s[40:41]
    ds_read_b128 v[28:31], v9 offset:7168
    ds_read_b128 v[32:35], v9 offset:7680
    s_mov_b64 exec, -1
    v_exp_f32 v50, v50
    v_exp_f32 v51, v51
    v_cvt_pk_bf16_f32 v74, v48, v49
    v_exp_f32 v52, v52
    v_exp_f32 v53, v53
    v_cvt_pk_bf16_f32 v75, v50, v51
    v_exp_f32 v54, v54
    v_exp_f32 v55, v55
    v_cvt_pk_bf16_f32 v76, v52, v53
    s_waitcnt lgkmcnt(3)
    v_mfma_f32_32x32x16_bf16 v[36:51], v[12:15], v[4:7], v[100:115]
    ds_read_b128 v[12:15], v8 offset:12288
    v_exp_f32 v56, v56
    v_exp_f32 v57, v57
    v_cvt_pk_bf16_f32 v77, v54, v55
    v_exp_f32 v58, v58
    v_exp_f32 v59, v59
    v_cvt_pk_bf16_f32 v78, v56, v57
    v_mfma_f32_32x32x16_bf16 v[84:99], v[20:23], v[68:71], v[84:99]
    v_exp_f32 v60, v60
    v_exp_f32 v61, v61
    v_cvt_pk_bf16_f32 v79, v58, v59
    v_exp_f32 v62, v62
    v_exp_f32 v63, v63
    v_cvt_pk_bf16_f32 v80, v60, v61
    v_exp_f32 v64, v64
    v_exp_f32 v65, v65
    v_cvt_pk_bf16_f32 v81, v62, v63
    v_mfma_f32_32x32x16_bf16 v[84:99], v[24:27], v[72:75], v[84:99]
    s_mov_b64 exec, s[40:41]
    ds_read_b128 v[20:23], v9 offset:9216
    ds_read_b128 v[24:27], v9 offset:9728
    s_mov_b64 exec, -1
    v_exp_f32 v66, v66
    v_exp_f32 v67, v67
    v_cvt_pk_bf16_f32 v82, v64, v65
    v_exp_f32 v36, v36
    v_exp_f32 v37, v37
    v_cvt_pk_bf16_f32 v83, v66, v67
    v_exp_f32 v38, v38
    v_exp_f32 v39, v39
    v_cvt_pk_bf16_f32 v68, v36, v37
    s_waitcnt lgkmcnt(3)
    v_mfma_f32_32x32x16_bf16 v[52:67], v[16:19], v[4:7], v[100:115]
    ds_read_b128 v[16:19], v8 offset:14336
    v_exp_f32 v40, v40
    v_exp_f32 v41, v41
    v_cvt_pk_bf16_f32 v69, v38, v39
    v_exp_f32 v42, v42
    v_exp_f32 v43, v43
    v_cvt_pk_bf16_f32 v70, v40, v41
    v_mfma_f32_32x32x16_bf16 v[84:99], v[28:31], v[76:79], v[84:99]
    v_exp_f32 v44, v44
    v_exp_f32 v45, v45
    v_cvt_pk_bf16_f32 v71, v42, v43
    v_exp_f32 v46, v46
    v_exp_f32 v47, v47
    v_cvt_pk_bf16_f32 v72, v44, v45
    v_exp_f32 v48, v48
    v_exp_f32 v49, v49
    v_cvt_pk_bf16_f32 v73, v46, v47
    v_mfma_f32_32x32x16_bf16 v[84:99], v[32:35], v[80:83], v[84:99]
    s_mov_b64 exec, s[40:41]
    ds_read_b128 v[28:31], v9 offset:11264
    ds_read_b128 v[32:35], v9 offset:11776
    s_mov_b64 exec, -1
    v_exp_f32 v50, v50
    v_exp_f32 v51, v51
    v_cvt_pk_bf16_f32 v74, v48, v49
    v_exp_f32 v52, v52
    v_exp_f32 v53, v53
    v_cvt_pk_bf16_f32 v75, v50, v51
    v_exp_f32 v54, v54
    v_exp_f32 v55, v55
    v_cvt_pk_bf16_f32 v76, v52, v53
    s_waitcnt lgkmcnt(3)
    v_mfma_f32_32x32x16_bf16 v[36:51], v[12:15], v[4:7], v[100:115]
    ds_read_b128 v[12:15], v8 offset:16384
    v_exp_f32 v56, v56
    v_exp_f32 v57, v57
    v_cvt_pk_bf16_f32 v77, v54, v55
    v_exp_f32 v58, v58
    v_exp_f32 v59, v59
    v_cvt_pk_bf16_f32 v78, v56, v57
    v_mfma_f32_32x32x16_bf16 v[84:99], v[20:23], v[68:71], v[84:99]
    v_exp_f32 v60, v60
    v_exp_f32 v61, v61
    v_cvt_pk_bf16_f32 v79, v58, v59
    v_exp_f32 v62, v62
    v_exp_f32 v63, v63
    v_cvt_pk_bf16_f32 v80, v60, v61
    v_exp_f32 v64, v64
    v_exp_f32 v65, v65
    v_cvt_pk_bf16_f32 v81, v62, v63
    v_mfma_f32_32x32x16_bf16 v[84:99], v[24:27], v[72:75], v[84:99]
    s_mov_b64 exec, s[40:41]
    ds_read_b128 v[20:23], v9 offset:13312
    ds_read_b128 v[24:27], v9 offset:13824
    s_mov_b64 exec, -1
    v_exp_f32 v66, v66
    v_exp_f32 v67, v67
    v_cvt_pk_bf16_f32 v82, v64, v65
    v_exp_f32 v36, v36
    v_exp_f32 v37, v37
    v_cvt_pk_bf16_f32 v83, v66, v67
    v_exp_f32 v38, v38
    v_exp_f32 v39, v39
    v_cvt_pk_bf16_f32 v68, v36, v37
    s_waitcnt lgkmcnt(3)
    v_mfma_f32_32x32x16_bf16 v[52:67], v[16:19], v[4:7], v[100:115]
    ds_read_b128 v[16:19], v8 offset:18432
    v_exp_f32 v40, v40
    v_exp_f32 v41, v41
    v_cvt_pk_bf16_f32 v69, v38, v39
    v_exp_f32 v42, v42
    v_exp_f32 v43, v43
    v_cvt_pk_bf16_f32 v70, v40, v41
    v_mfma_f32_32x32x16_bf16 v[84:99], v[28:31], v[76:79], v[84:99]
    v_exp_f32 v44, v44
    v_exp_f32 v45, v45
    v_cvt_pk_bf16_f32 v71, v42, v43
    v_exp_f32 v46, v46
    v_exp_f32 v47, v47
    v_cvt_pk_bf16_f32 v72, v44, v45
    v_exp_f32 v48, v48
    v_exp_f32 v49, v49
    v_cvt_pk_bf16_f32 v73, v46, v47
    v_mfma_f32_32x32x16_bf16 v[84:99], v[32:35], v[80:83], v[84:99]
    s_mov_b64 exec, s[40:41]
    ds_read_b128 v[28:31], v9 offset:15360
    ds_read_b128 v[32:35], v9 offset:15872
    s_mov_b64 exec, -1
    v_exp_f32 v50, v50
    v_exp_f32 v51, v51
    v_cvt_pk_bf16_f32 v74, v48, v49
    v_exp_f32 v52, v52
    v_exp_f32 v53, v53
    v_cvt_pk_bf16_f32 v75, v50, v51
    v_exp_f32 v54, v54
    v_exp_f32 v55, v55
    v_cvt_pk_bf16_f32 v76, v52, v53
    s_waitcnt lgkmcnt(3)
    v_mfma_f32_32x32x16_bf16 v[36:51], v[12:15], v[4:7], v[100:115]
    ds_read_b128 v[12:15], v8 offset:20480
    v_exp_f32 v56, v56
    v_exp_f32 v57, v57
    v_cvt_pk_bf16_f32 v77, v54, v55
    v_exp_f32 v58, v58
    v_exp_f32 v59, v59
    v_cvt_pk_bf16_f32 v78, v56, v57
    v_mfma_f32_32x32x16_bf16 v[84:99], v[20:23], v[68:71], v[84:99]
    v_exp_f32 v60, v60
    v_exp_f32 v61, v61
    v_cvt_pk_bf16_f32 v79, v58, v59
    v_exp_f32 v62, v62
    v_exp_f32 v63, v63
    v_cvt_pk_bf16_f32 v80, v60, v61
    v_exp_f32 v64, v64
    v_exp_f32 v65, v65
    v_cvt_pk_bf16_f32 v81, v62, v63
    v_mfma_f32_32x32x16_bf16 v[84:99], v[24:27], v[72:75], v[84:99]
    s_mov_b64 exec, s[40:41]
    ds_read_b128 v[20:23], v9 offset:17408
    ds_read_b128 v[24:27], v9 offset:17920
    s_mov_b64 exec, -1
    v_exp_f32 v66, v66
    v_exp_f32 v67, v67
    v_cvt_pk_bf16_f32 v82, v64, v65
    v_add_u32 v8, 16384, v8
    v_add_u32 v9, 16384, v9
    s_sub_u32 s42, s42, 1
    s_cmp_lg_u32 s42, 0
    s_cbranch_scc1 L_att_loopB
    v_cvt_pk_bf16_f32 v83, v66, v67
    s_waitcnt lgkmcnt(0)
    v_mfma_f32_32x32x16_bf16 v[84:99], v[28:31], v[76:79], v[84:99]
    v_mfma_f32_32x32x16_bf16 v[84:99], v[32:35], v[80:83], v[84:99]
    v_subrev_u32 v8, 131072, v8
    v_subrev_u32 v9, 131072, v9
    s_cmp_lg_u32 s43, 0
    s_cbranch_scc1 L_att_done
    s_nop 7
    v_max3_f32 v118, abs(v84), abs(v85), abs(v86)
    v_max3_f32 v119, abs(v87), abs(v88), abs(v89)
    v_mov_b32 v116, 0x1f800000
    v_max3_f32 v118, v118, abs(v90), abs(v91)
    v_mov_b32 v117, 0x5f800000
    v_max_f32 v118, v118, v119
    v_cmp_ge_f32 s[44:45], v92, v116
    v_mov_b32 v119, 0x7f800000
    v_cmp_le_f32 s[46:47], v92, v117
    v_cmp_lt_f32 vcc, v118, v119
    s_nop 2
    s_and_b64 s[44:45], s[44:45], s[46:47]
    s_and_b64 s[44:45], s[44:45], vcc
    s_cmp_eq_u64 s[44:45], exec
    s_cbranch_scc1 L_att_done
    v_mov_b32 v116, 0xff800000
    v_mov_b32 v117, v8
    s_mov_b32 s42, 64
L_att_mx:
    ds_read_b128 v[12:15], v117
    v_add_u32 v117, 2048, v117
    s_waitcnt lgkmcnt(0)
    v_mfma_f32_32x32x16_bf16 v[36:51], v[12:15], v[4:7], 0
    s_nop 11
    v_max3_f32 v116, v116, v36, v37
    v_max3_f32 v116, v116, v38, v39
    v_max3_f32 v116, v116, v40, v41
    v_max3_f32 v116, v116, v42, v43
    v_max3_f32 v116, v116, v44, v45
    v_max3_f32 v116, v116, v46, v47
    v_max3_f32 v116, v116, v48, v49
    v_max3_f32 v116, v116, v50, v51
    s_sub_u32 s42, s42, 1
    s_cmp_lg_u32 s42, 0
    s_cbranch_scc1 L_att_mx
    v_mov_b32 v117, v116
    s_nop 1
    v_permlane32_swap_b32 v116, v117
    v_max_f32 v116, v116, v117
    v_sub_f32 v100, 0, v116
    v_sub_f32 v101, 0, v116
    v_sub_f32 v102, 0, v116
    v_sub_f32 v103, 0, v116
    v_sub_f32 v104, 0, v116
    v_sub_f32 v105, 0, v116
    v_sub_f32 v106, 0, v116
    v_sub_f32 v107, 0, v116
    v_sub_f32 v108, 0, v116
    v_sub_f32 v109, 0, v116
    v_sub_f32 v110, 0, v116
    v_sub_f32 v111, 0, v116
    v_sub_f32 v112, 0, v116
    v_sub_f32 v113, 0, v116
    v_sub_f32 v114, 0, v116
    v_sub_f32 v115, 0, v116
    v_mov_b32 v84, 0
    v_mov_b32 v85, 0
    v_mov_b32 v86, 0
    v_mov_b32 v87, 0
    v_mov_b32 v88, 0
    v_mov_b32 v89, 0
    v_mov_b32 v90, 0
    v_mov_b32 v91, 0
    v_mov_b32 v92, 0
    v_mov_b32 v93, 0
    v_mov_b32 v94, 0
    v_mov_b32 v95, 0
    v_mov_b32 v96, 0
    v_mov_b32 v97, 0
    v_mov_b32 v98, 0
    v_mov_b32 v99, 0
    v_mov_b32 v76, 0
    v_mov_b32 v77, 0
    v_mov_b32 v78, 0
    v_mov_b32 v79, 0
    v_mov_b32 v80, 0
    v_mov_b32 v81, 0
    v_mov_b32 v82, 0
    v_mov_b32 v83, 0
    v_mov_b32 v66, 0
    v_mov_b32 v67, 0
    s_mov_b32 s43, 1
    s_branch L_att_pass
L_att_landed:
    s_mov_b32 s64, 2097152
L_lp15:
    ds_read_b32 v133, v3 offset:4
    s_waitcnt lgkmcnt(0)
    v_cmp_gt_u32 vcc, 4, v133
    s_nop 4
    s_cbranch_vccz L_lpx16
    s_sub_u32 s64, s64, 1
    s_cmp_eq_u32 s64, 0
    s_cbranch_scc1 L_lpx16
    s_sleep 1
    s_branch L_lp15
L_lpx16:
    s_branch L_att_landed_ret
L_att_done:
    s_waitcnt vmcnt(0)
    s_nop 7
    v_rcp_f32 v116, v92
    s_nop 0
    v_mul_f32 v116, v116, v132
    v_mul_f32 v84, v84, v116
    v_mul_f32 v85, v85, v116
    v_mul_f32 v86, v86, v116
    v_mul_f32 v87, v87, v116
    v_mul_f32 v88, v88, v116
    v_mul_f32 v89, v89, v116
    v_mul_f32 v90, v90, v116
    v_mul_f32 v91, v91, v116
    v_cvt_pk_bf16_f32 v120, v84, v85
    v_cvt_pk_bf16_f32 v121, v86, v87
    v_cvt_pk_bf16_f32 v122, v88, v89
    v_cvt_pk_bf16_f32 v123, v90, v91
    v_min_u32 v120, 0xfffffffe, v120
    v_min_u32 v121, 0xfffffffe, v121
    v_min_u32 v122, 0xfffffffe, v122
    v_min_u32 v123, 0xfffffffe, v123
    v_lshlrev_b32 v2, 4, v0
    buffer_store_dwordx4 v[120:123], v2, s[12:15], s29 offen sc1
    v_mov_b32 v9, 1
    s_mov_b64 exec, 1
    ds_add_u32 v3, v9 offset:16
    s_mov_b64 exec, -1
    s_endpgm
.p2align 7
L_G:
    s_sub_u32 s28, s20, 8
    s_load_dwordx2 s[48:49], s[0:1], 56
    s_mov_b32 s50, 0x1c0000
    s_mov_b32 s51, 0x00020000
    s_load_dwordx2 s[52:53], s[0:1], 32
    s_mov_b32 s54, 0x80000
    s_mov_b32 s55, 0x00020000
    s_load_dwordx2 s[56:57], s[0:1], 72
    s_mov_b32 s58, 0x200000
    s_mov_b32 s59, 0x00020000
    s_cmp_ge_u32 s22, 14
    s_cbranch_scc1 L_KV
    s_barrier
    s_barrier
    s_and_b32 s24, s28, 1
    s_lshr_b32 s25, s28, 1
    v_and_b32 v16, 31, v0
    v_bfe_u32 v17, v0, 1, 3
    v_lshrrev_b32 v18, 5, v0
    v_xor_b32 v17, v17, v18
    v_lshlrev_b32 v17, 4, v17
    v_lshl_add_u32 v8, v16, 7, v17
    s_lshl_b32 s26, s24, 13
    v_add_u32 v8, s26, v8
    v_xor_b32 v9, 32, v8
    v_xor_b32 v10, 64, v8
    v_xor_b32 v11, 96, v8
    v_bfe_u32 v16, v0, 2, 2
    v_lshl_add_u32 v17, v18, 3, v16
    v_lshlrev_b32 v12, 8, v17
    s_lshl_b32 s26, s25, 1
    v_xor_b32 v16, s26, v16
    v_lshl_add_u32 v12, v16, 6, v12
    v_bfe_u32 v17, v0, 4, 1
    v_lshl_add_u32 v12, v17, 5, v12
    v_bfe_u32 v17, v0, 1, 1
    v_lshl_add_u32 v12, v17, 4, v12
    v_and_b32 v17, 1, v0
    v_lshl_add_u32 v12, v17, 3, v12
    v_add_u32 v12, 16384, v12
    v_xor_b32 v13, 64, v12
    v_lshrrev_b32 v16, 4, v0
    v_lshlrev_b32 v17, 2, v16
    v_and_b32 v19, 15, v0
    v_xor_b32 v17, v17, v19
    v_lshlrev_b32 v17, 4, v17
    s_lshl_b32 s26, s28, 4
    v_add_u32 v16, s26, v16
    v_mul_u32_u24 v16, 3584, v16
    v_add_u32 v14, v16, v17
    s_lshl_b32 s26, s22, 8
    v_add_u32 v14, s26, v14
    s_lshl_b32 s30, s28, 12
    s_add_u32 s30, s30, 16384
    s_setprio 3
    s_mov_b32 s34, 0
    s_mov_b32 s36, 36864
    v_mov_b32 v64, 0
    v_mov_b32 v65, 0
    v_mov_b32 v66, 0
    v_mov_b32 v67, 0
    v_mov_b32 v68, 0
    v_mov_b32 v69, 0
    v_mov_b32 v70, 0
    v_mov_b32 v71, 0
    v_mov_b32 v72, 0
    v_mov_b32 v73, 0
    v_mov_b32 v74, 0
    v_mov_b32 v75, 0
    v_mov_b32 v76, 0
    v_mov_b32 v77, 0
    v_mov_b32 v78, 0
    v_mov_b32 v79, 0
    v_mov_b32 v80, 0
    v_mov_b32 v81, 0
    v_mov_b32 v82, 0
    v_mov_b32 v83, 0
    v_mov_b32 v84, 0
    v_mov_b32 v85, 0
    v_mov_b32 v86, 0
    v_mov_b32 v87, 0
    v_mov_b32 v88, 0
    v_mov_b32 v89, 0
    v_mov_b32 v90, 0
    v_mov_b32 v91, 0
    v_mov_b32 v92, 0
    v_mov_b32 v93, 0
    v_mov_b32 v94, 0
    v_mov_b32 v95, 0
    v_mov_b32 v96, 0
    v_mov_b32 v97, 0
    v_mov_b32 v98, 0
    v_mov_b32 v99, 0
    v_mov_b32 v100, 0
    v_mov_b32 v101, 0
    v_mov_b32 v102, 0
    v_mov_b32 v103, 0
    v_mov_b32 v104, 0
    v_mov_b32 v105, 0
    v_mov_b32 v106, 0
    v_mov_b32 v107, 0
    v_mov_b32 v108, 0
    v_mov_b32 v109, 0
    v_mov_b32 v110, 0
    v_mov_b32 v111, 0
    v_mov_b32 v112, 0
    v_mov_b32 v113, 0
    v_mov_b32 v114, 0
    v_mov_b32 v115, 0
    v_mov_b32 v116, 0
    v_mov_b32 v117, 0
    v_mov_b32 v118, 0
    v_mov_b32 v119, 0
    v_mov_b32 v120, 0
    v_mov_b32 v121, 0
    v_mov_b32 v122, 0
    v_mov_b32 v123, 0
    v_mov_b32 v124, 0
    v_mov_b32 v125, 0
    v_mov_b32 v126, 0
    v_mov_b32 v127, 0
    v_mov_b32 v128, 0
    v_mov_b32 v129, 0
    v_mov_b32 v130, 0
    v_mov_b32 v131, 0
    v_mov_b32 v132, 0
    v_mov_b32 v133, 0
    v_mov_b32 v134, 0
    v_mov_b32 v135, 0
    v_mov_b32 v136, 0
    v_mov_b32 v137, 0
    v_mov_b32 v138, 0
    v_mov_b32 v139, 0
    v_mov_b32 v140, 0
    v_mov_b32 v141, 0
    v_mov_b32 v142, 0
    v_mov_b32 v143, 0
    v_mov_b32 v144, 0
    v_mov_b32 v145, 0
    v_mov_b32 v146, 0
    v_mov_b32 v147, 0
    v_mov_b32 v148, 0
    v_mov_b32 v149, 0
    v_mov_b32 v150, 0
    v_mov_b32 v151, 0
    v_mov_b32 v152, 0
    v_mov_b32 v153, 0
    v_mov_b32 v154, 0
    v_mov_b32 v155, 0
    v_mov_b32 v156, 0
    v_mov_b32 v157, 0
    v_mov_b32 v158, 0
    v_mov_b32 v159, 0
    s_mov_b32 s37, 36864
    s_mov_b32 s65, 4
.p2align 6
L_p0G:
    s_waitcnt lgkmcnt(0)
    s_barrier
    ds_read_b64_tr_b16 v[32:33], v12 offset:0
    ds_read_b64_tr_b16 v[34:35], v12 offset:1024
    v_mfma_f32_32x32x16_bf16 v[64:79], v[128:131], v[136:139], v[64:79]
    ds_read_b64_tr_b16 v[36:37], v13 offset:0
    ds_read_b64_tr_b16 v[38:39], v13 offset:1024
    v_mfma_f32_32x32x16_bf16 v[80:95], v[128:131], v[140:143], v[80:95]
    ds_read_b128 v[40:43], v8 offset:0
    ds_read_b128 v[44:47], v8 offset:4096
    v_mfma_f32_32x32x16_bf16 v[96:111], v[132:135], v[136:139], v[96:111]
    ds_read_b64_tr_b16 v[48:49], v12 offset:4096
    ds_read_b64_tr_b16 v[50:51], v12 offset:5120
    v_mfma_f32_32x32x16_bf16 v[112:127], v[132:135], v[140:143], v[112:127]
    ds_read_b64_tr_b16 v[52:53], v13 offset:4096
    ds_read_b64_tr_b16 v[54:55], v13 offset:5120
    v_mfma_f32_32x32x16_bf16 v[64:79], v[144:147], v[152:155], v[64:79]
    ds_read_b128 v[56:59], v9 offset:0
    ds_read_b128 v[60:63], v9 offset:4096
    v_mfma_f32_32x32x16_bf16 v[80:95], v[144:147], v[156:159], v[80:95]
    s_waitcnt lgkmcnt(6)
    ds_read_b64_tr_b16 v[128:129], v12 offset:8192
    ds_read_b64_tr_b16 v[130:131], v12 offset:9216
    v_mfma_f32_32x32x16_bf16 v[96:111], v[148:151], v[152:155], v[96:111]
    ds_read_b64_tr_b16 v[132:133], v13 offset:8192
    ds_read_b64_tr_b16 v[134:135], v13 offset:9216
    v_mfma_f32_32x32x16_bf16 v[112:127], v[148:151], v[156:159], v[112:127]
    ds_read_b128 v[136:139], v10 offset:0
    ds_read_b128 v[140:143], v10 offset:4096
    v_mfma_f32_32x32x16_bf16 v[64:79], v[32:35], v[40:43], v[64:79]
    ds_read_b64_tr_b16 v[144:145], v12 offset:12288
    ds_read_b64_tr_b16 v[146:147], v12 offset:13312
    v_mfma_f32_32x32x16_bf16 v[80:95], v[32:35], v[44:47], v[80:95]
    s_waitcnt lgkmcnt(8)
    ds_read_b64_tr_b16 v[148:149], v13 offset:12288
    ds_read_b64_tr_b16 v[150:151], v13 offset:13312
    v_mfma_f32_32x32x16_bf16 v[96:111], v[36:39], v[40:43], v[96:111]
    ds_read_b128 v[152:155], v11 offset:0
    ds_read_b128 v[156:159], v11 offset:4096
    v_mfma_f32_32x32x16_bf16 v[112:127], v[36:39], v[44:47], v[112:127]
    v_mfma_f32_32x32x16_bf16 v[64:79], v[48:51], v[56:59], v[64:79]
    v_add_u32 v8, s37, v8
    v_add_u32 v9, s37, v9
    v_add_u32 v10, s37, v10
    v_mfma_f32_32x32x16_bf16 v[80:95], v[48:51], v[60:63], v[80:95]
    v_add_u32 v11, s37, v11
    v_add_u32 v12, s37, v12
    v_add_u32 v13, s37, v13
    v_mfma_f32_32x32x16_bf16 v[96:111], v[52:55], v[56:59], v[96:111]
    v_mfma_f32_32x32x16_bf16 v[112:127], v[52:55], v[60:63], v[112:127]
    s_waitcnt lgkmcnt(0)
    s_barrier
    ds_read_b64_tr_b16 v[32:33], v12 offset:0
    ds_read_b64_tr_b16 v[34:35], v12 offset:1024
    v_mfma_f32_32x32x16_bf16 v[64:79], v[128:131], v[136:139], v[64:79]
    ds_read_b64_tr_b16 v[36:37], v13 offset:0
    ds_read_b64_tr_b16 v[38:39], v13 offset:1024
    v_mfma_f32_32x32x16_bf16 v[80:95], v[128:131], v[140:143], v[80:95]
    ds_read_b128 v[40:43], v8 offset:0
    ds_read_b128 v[44:47], v8 offset:4096
    v_mfma_f32_32x32x16_bf16 v[96:111], v[132:135], v[136:139], v[96:111]
    ds_read_b64_tr_b16 v[48:49], v12 offset:4096
    ds_read_b64_tr_b16 v[50:51], v12 offset:5120
    v_mfma_f32_32x32x16_bf16 v[112:127], v[132:135], v[140:143], v[112:127]
    ds_read_b64_tr_b16 v[52:53], v13 offset:4096
    ds_read_b64_tr_b16 v[54:55], v13 offset:5120
    v_mfma_f32_32x32x16_bf16 v[64:79], v[144:147], v[152:155], v[64:79]
    ds_read_b128 v[56:59], v9 offset:0
    ds_read_b128 v[60:63], v9 offset:4096
    v_mfma_f32_32x32x16_bf16 v[80:95], v[144:147], v[156:159], v[80:95]
    s_waitcnt lgkmcnt(6)
    ds_read_b64_tr_b16 v[128:129], v12 offset:8192
    ds_read_b64_tr_b16 v[130:131], v12 offset:9216
    v_mfma_f32_32x32x16_bf16 v[96:111], v[148:151], v[152:155], v[96:111]
    ds_read_b64_tr_b16 v[132:133], v13 offset:8192
    ds_read_b64_tr_b16 v[134:135], v13 offset:9216
    v_mfma_f32_32x32x16_bf16 v[112:127], v[148:151], v[156:159], v[112:127]
    ds_read_b128 v[136:139], v10 offset:0
    ds_read_b128 v[140:143], v10 offset:4096
    v_mfma_f32_32x32x16_bf16 v[64:79], v[32:35], v[40:43], v[64:79]
    ds_read_b64_tr_b16 v[144:145], v12 offset:12288
    ds_read_b64_tr_b16 v[146:147], v12 offset:13312
    v_mfma_f32_32x32x16_bf16 v[80:95], v[32:35], v[44:47], v[80:95]
    s_waitcnt lgkmcnt(8)
    ds_read_b64_tr_b16 v[148:149], v13 offset:12288
    ds_read_b64_tr_b16 v[150:151], v13 offset:13312
    v_mfma_f32_32x32x16_bf16 v[96:111], v[36:39], v[40:43], v[96:111]
    ds_read_b128 v[152:155], v11 offset:0
    ds_read_b128 v[156:159], v11 offset:4096
    v_mfma_f32_32x32x16_bf16 v[112:127], v[36:39], v[44:47], v[112:127]
    v_mfma_f32_32x32x16_bf16 v[64:79], v[48:51], v[56:59], v[64:79]
    v_add_u32 v8, s36, v8
    v_add_u32 v9, s36, v9
    v_add_u32 v10, s36, v10
    v_mfma_f32_32x32x16_bf16 v[80:95], v[48:51], v[60:63], v[80:95]
    v_add_u32 v11, s36, v11
    v_add_u32 v12, s36, v12
    v_add_u32 v13, s36, v13
    v_mfma_f32_32x32x16_bf16 v[96:111], v[52:55], v[56:59], v[96:111]
    s_xor_b32 s36, s36, 0xfffec000
    s_sub_u32 s65, s65, 1
    s_cmp_lg_u32 s65, 0
    v_mfma_f32_32x32x16_bf16 v[112:127], v[52:55], v[60:63], v[112:127]
    s_cbranch_scc1 L_p0G
    s_waitcnt lgkmcnt(0)
    s_barrier
    v_mfma_f32_32x32x16_bf16 v[64:79], v[128:131], v[136:139], v[64:79]
    v_mfma_f32_32x32x16_bf16 v[80:95], v[128:131], v[140:143], v[80:95]
    v_mfma_f32_32x32x16_bf16 v[96:111], v[132:135], v[136:139], v[96:111]
    v_mfma_f32_32x32x16_bf16 v[112:127], v[132:135], v[140:143], v[112:127]
    v_mfma_f32_32x32x16_bf16 v[64:79], v[144:147], v[152:155], v[64:79]
    v_mfma_f32_32x32x16_bf16 v[80:95], v[144:147], v[156:159], v[80:95]
    v_mfma_f32_32x32x16_bf16 v[96:111], v[148:151], v[152:155], v[96:111]
    v_mfma_f32_32x32x16_bf16 v[112:127], v[148:151], v[156:159], v[112:127]
    v_lshlrev_b32 v8, 4, v0
    s_and_b32 s24, s28, 1
    s_lshl_b32 s24, s24, 1
    s_lshl_b32 s25, s21, 2
    s_add_u32 s24, s24, s25
    s_mul_i32 s24, s24, 112
    s_lshl_b32 s25, s22, 3
    s_add_u32 s24, s24, s25
    s_lshr_b32 s25, s28, 1
    s_lshl_b32 s25, s25, 2
    s_add_u32 s24, s24, s25
    s_lshl_b32 s24, s24, 10
    s_add_u32 s24, s24, 3145728
    s_mov_b32 s26, 0xbfb8aa3b
    v_mul_f32 v32, s26, v64
    v_mul_f32 v33, s26, v65
    v_mul_f32 v34, s26, v66
    v_mul_f32 v35, s26, v67
    v_mul_f32 v36, s26, v68
    v_mul_f32 v37, s26, v69
    v_mul_f32 v38, s26, v70
    v_mul_f32 v39, s26, v71
    v_mul_f32 v40, s26, v72
    v_mul_f32 v41, s26, v73
    v_mul_f32 v42, s26, v74
    v_mul_f32 v43, s26, v75
    v_mul_f32 v44, s26, v76
    v_mul_f32 v45, s26, v77
    v_mul_f32 v46, s26, v78
    v_mul_f32 v47, s26, v79
    v_exp_f32 v32, v32
    v_exp_f32 v33, v33
    v_exp_f32 v34, v34
    v_exp_f32 v35, v35
    v_exp_f32 v36, v36
    v_exp_f32 v37, v37
    v_exp_f32 v38, v38
    v_exp_f32 v39, v39
    v_exp_f32 v40, v40
    v_exp_f32 v41, v41
    v_exp_f32 v42, v42
    v_exp_f32 v43, v43
    v_exp_f32 v44, v44
    v_exp_f32 v45, v45
    v_exp_f32 v46, v46
    v_exp_f32 v47, v47
    v_add_f32 v32, 1.0, v32
    v_add_f32 v33, 1.0, v33
    v_add_f32 v34, 1.0, v34
    v_add_f32 v35, 1.0, v35
    v_add_f32 v36, 1.0, v36
    v_add_f32 v37, 1.0, v37
    v_add_f32 v38, 1.0, v38
    v_add_f32 v39, 1.0, v39
    v_add_f32 v40, 1.0, v40
    v_add_f32 v41, 1.0, v41
    v_add_f32 v42, 1.0, v42
    v_add_f32 v43, 1.0, v43
    v_add_f32 v44, 1.0, v44
    v_add_f32 v45, 1.0, v45
    v_add_f32 v46, 1.0, v46
    v_add_f32 v47, 1.0, v47
    v_rcp_f32 v32, v32
    v_rcp_f32 v33, v33
    v_rcp_f32 v34, v34
    v_rcp_f32 v35, v35
    v_rcp_f32 v36, v36
    v_rcp_f32 v37, v37
    v_rcp_f32 v38, v38
    v_rcp_f32 v39, v39
    v_rcp_f32 v40, v40
    v_rcp_f32 v41, v41
    v_rcp_f32 v42, v42
    v_rcp_f32 v43, v43
    v_rcp_f32 v44, v44
    v_rcp_f32 v45, v45
    v_rcp_f32 v46, v46
    v_rcp_f32 v47, v47
    v_mul_f32 v32, v64, v32
    v_mul_f32 v33, v65, v33
    v_mul_f32 v34, v66, v34
    v_mul_f32 v35, v67, v35
    v_mul_f32 v36, v68, v36
    v_mul_f32 v37, v69, v37
    v_mul_f32 v38, v70, v38
    v_mul_f32 v39, v71, v39
    v_mul_f32 v40, v72, v40
    v_mul_f32 v41, v73, v41
    v_mul_f32 v42, v74, v42
    v_mul_f32 v43, v75, v43
    v_mul_f32 v44, v76, v44
    v_mul_f32 v45, v77, v45
    v_mul_f32 v46, v78, v46
    v_mul_f32 v47, v79, v47
    v_cvt_pk_bf16_f32 v64, v32, v33
    v_cvt_pk_bf16_f32 v65, v34, v35
    v_cvt_pk_bf16_f32 v66, v36, v37
    v_cvt_pk_bf16_f32 v67, v38, v39
    v_cvt_pk_bf16_f32 v68, v40, v41
    v_cvt_pk_bf16_f32 v69, v42, v43
    v_cvt_pk_bf16_f32 v70, v44, v45
    v_cvt_pk_bf16_f32 v71, v46, v47
    v_mul_f32 v48, s26, v80
    v_mul_f32 v49, s26, v81
    v_mul_f32 v50, s26, v82
    v_mul_f32 v51, s26, v83
    v_mul_f32 v52, s26, v84
    v_mul_f32 v53, s26, v85
    v_mul_f32 v54, s26, v86
    v_mul_f32 v55, s26, v87
    v_mul_f32 v56, s26, v88
    v_mul_f32 v57, s26, v89
    v_mul_f32 v58, s26, v90
    v_mul_f32 v59, s26, v91
    v_mul_f32 v60, s26, v92
    v_mul_f32 v61, s26, v93
    v_mul_f32 v62, s26, v94
    v_mul_f32 v63, s26, v95
    v_exp_f32 v48, v48
    v_exp_f32 v49, v49
    v_exp_f32 v50, v50
    v_exp_f32 v51, v51
    v_exp_f32 v52, v52
    v_exp_f32 v53, v53
    v_exp_f32 v54, v54
    v_exp_f32 v55, v55
    v_exp_f32 v56, v56
    v_exp_f32 v57, v57
    v_exp_f32 v58, v58
    v_exp_f32 v59, v59
    v_exp_f32 v60, v60
    v_exp_f32 v61, v61
    v_exp_f32 v62, v62
    v_exp_f32 v63, v63
    v_add_f32 v48, 1.0, v48
    v_add_f32 v49, 1.0, v49
    v_add_f32 v50, 1.0, v50
    v_add_f32 v51, 1.0, v51
    v_add_f32 v52, 1.0, v52
    v_add_f32 v53, 1.0, v53
    v_add_f32 v54, 1.0, v54
    v_add_f32 v55, 1.0, v55
    v_add_f32 v56, 1.0, v56
    v_add_f32 v57, 1.0, v57
    v_add_f32 v58, 1.0, v58
    v_add_f32 v59, 1.0, v59
    v_add_f32 v60, 1.0, v60
    v_add_f32 v61, 1.0, v61
    v_add_f32 v62, 1.0, v62
    v_add_f32 v63, 1.0, v63
    v_rcp_f32 v48, v48
    v_rcp_f32 v49, v49
    v_rcp_f32 v50, v50
    v_rcp_f32 v51, v51
    v_rcp_f32 v52, v52
    v_rcp_f32 v53, v53
    v_rcp_f32 v54, v54
    v_rcp_f32 v55, v55
    v_rcp_f32 v56, v56
    v_rcp_f32 v57, v57
    v_rcp_f32 v58, v58
    v_rcp_f32 v59, v59
    v_rcp_f32 v60, v60
    v_rcp_f32 v61, v61
    v_rcp_f32 v62, v62
    v_rcp_f32 v63, v63
    v_mul_f32 v48, v80, v48
    v_mul_f32 v49, v81, v49
    v_mul_f32 v50, v82, v50
    v_mul_f32 v51, v83, v51
    v_mul_f32 v52, v84, v52
    v_mul_f32 v53, v85, v53
    v_mul_f32 v54, v86, v54
    v_mul_f32 v55, v87, v55
    v_mul_f32 v56, v88, v56
    v_mul_f32 v57, v89, v57
    v_mul_f32 v58, v90, v58
    v_mul_f32 v59, v91, v59
    v_mul_f32 v60, v92, v60
    v_mul_f32 v61, v93, v61
    v_mul_f32 v62, v94, v62
    v_mul_f32 v63, v95, v63
    v_cvt_pk_bf16_f32 v80, v48, v49
    v_cvt_pk_bf16_f32 v81, v50, v51
    v_cvt_pk_bf16_f32 v82, v52, v53
    v_cvt_pk_bf16_f32 v83, v54, v55
    v_cvt_pk_bf16_f32 v84, v56, v57
    v_cvt_pk_bf16_f32 v85, v58, v59
    v_cvt_pk_bf16_f32 v86, v60, v61
    v_cvt_pk_bf16_f32 v87, v62, v63
    v_mul_f32 v32, s26, v96
    v_mul_f32 v33, s26, v97
    v_mul_f32 v34, s26, v98
    v_mul_f32 v35, s26, v99
    v_mul_f32 v36, s26, v100
    v_mul_f32 v37, s26, v101
    v_mul_f32 v38, s26, v102
    v_mul_f32 v39, s26, v103
    v_mul_f32 v40, s26, v104
    v_mul_f32 v41, s26, v105
    v_mul_f32 v42, s26, v106
    v_mul_f32 v43, s26, v107
    v_mul_f32 v44, s26, v108
    v_mul_f32 v45, s26, v109
    v_mul_f32 v46, s26, v110
    v_mul_f32 v47, s26, v111
    v_exp_f32 v32, v32
    v_exp_f32 v33, v33
    v_exp_f32 v34, v34
    v_exp_f32 v35, v35
    v_exp_f32 v36, v36
    v_exp_f32 v37, v37
    v_exp_f32 v38, v38
    v_exp_f32 v39, v39
    v_exp_f32 v40, v40
    v_exp_f32 v41, v41
    v_exp_f32 v42, v42
    v_exp_f32 v43, v43
    v_exp_f32 v44, v44
    v_exp_f32 v45, v45
    v_exp_f32 v46, v46
    v_exp_f32 v47, v47
    v_add_f32 v32, 1.0, v32
    v_add_f32 v33, 1.0, v33
    v_add_f32 v34, 1.0, v34
    v_add_f32 v35, 1.0, v35
    v_add_f32 v36, 1.0, v36
    v_add_f32 v37, 1.0, v37
    v_add_f32 v38, 1.0, v38
    v_add_f32 v39, 1.0, v39
    v_add_f32 v40, 1.0, v40
    v_add_f32 v41, 1.0, v41
    v_add_f32 v42, 1.0, v42
    v_add_f32 v43, 1.0, v43
    v_add_f32 v44, 1.0, v44
    v_add_f32 v45, 1.0, v45
    v_add_f32 v46, 1.0, v46
    v_add_f32 v47, 1.0, v47
    v_rcp_f32 v32, v32
    v_rcp_f32 v33, v33
    v_rcp_f32 v34, v34
    v_rcp_f32 v35, v35
    v_rcp_f32 v36, v36
    v_rcp_f32 v37, v37
    v_rcp_f32 v38, v38
    v_rcp_f32 v39, v39
    v_rcp_f32 v40, v40
    v_rcp_f32 v41, v41
    v_rcp_f32 v42, v42
    v_rcp_f32 v43, v43
    v_rcp_f32 v44, v44
    v_rcp_f32 v45, v45
    v_rcp_f32 v46, v46
    v_rcp_f32 v47, v47
    v_mul_f32 v32, v96, v32
    v_mul_f32 v33, v97, v33
    v_mul_f32 v34, v98, v34
    v_mul_f32 v35, v99, v35
    v_mul_f32 v36, v100, v36
    v_mul_f32 v37, v101, v37
    v_mul_f32 v38, v102, v38
    v_mul_f32 v39, v103, v39
    v_mul_f32 v40, v104, v40
    v_mul_f32 v41, v105, v41
    v_mul_f32 v42, v106, v42
    v_mul_f32 v43, v107, v43
    v_mul_f32 v44, v108, v44
    v_mul_f32 v45, v109, v45
    v_mul_f32 v46, v110, v46
    v_mul_f32 v47, v111, v47
    v_cvt_pk_bf16_f32 v96, v32, v33
    v_cvt_pk_bf16_f32 v97, v34, v35
    v_cvt_pk_bf16_f32 v98, v36, v37
    v_cvt_pk_bf16_f32 v99, v38, v39
    v_cvt_pk_bf16_f32 v100, v40, v41
    v_cvt_pk_bf16_f32 v101, v42, v43
    v_cvt_pk_bf16_f32 v102, v44, v45
    v_cvt_pk_bf16_f32 v103, v46, v47
    v_mul_f32 v48, s26, v112
    v_mul_f32 v49, s26, v113
    v_mul_f32 v50, s26, v114
    v_mul_f32 v51, s26, v115
    v_mul_f32 v52, s26, v116
    v_mul_f32 v53, s26, v117
    v_mul_f32 v54, s26, v118
    v_mul_f32 v55, s26, v119
    v_mul_f32 v56, s26, v120
    v_mul_f32 v57, s26, v121
    v_mul_f32 v58, s26, v122
    v_mul_f32 v59, s26, v123
    v_mul_f32 v60, s26, v124
    v_mul_f32 v61, s26, v125
    v_mul_f32 v62, s26, v126
    v_mul_f32 v63, s26, v127
    v_exp_f32 v48, v48
    v_exp_f32 v49, v49
    v_exp_f32 v50, v50
    v_exp_f32 v51, v51
    v_exp_f32 v52, v52
    v_exp_f32 v53, v53
    v_exp_f32 v54, v54
    v_exp_f32 v55, v55
    v_exp_f32 v56, v56
    v_exp_f32 v57, v57
    v_exp_f32 v58, v58
    v_exp_f32 v59, v59
    v_exp_f32 v60, v60
    v_exp_f32 v61, v61
    v_exp_f32 v62, v62
    v_exp_f32 v63, v63
    v_add_f32 v48, 1.0, v48
    v_add_f32 v49, 1.0, v49
    v_add_f32 v50, 1.0, v50
    v_add_f32 v51, 1.0, v51
    v_add_f32 v52, 1.0, v52
    v_add_f32 v53, 1.0, v53
    v_add_f32 v54, 1.0, v54
    v_add_f32 v55, 1.0, v55
    v_add_f32 v56, 1.0, v56
    v_add_f32 v57, 1.0, v57
    v_add_f32 v58, 1.0, v58
    v_add_f32 v59, 1.0, v59
    v_add_f32 v60, 1.0, v60
    v_add_f32 v61, 1.0, v61
    v_add_f32 v62, 1.0, v62
    v_add_f32 v63, 1.0, v63
    v_rcp_f32 v48, v48
    v_rcp_f32 v49, v49
    v_rcp_f32 v50, v50
    v_rcp_f32 v51, v51
    v_rcp_f32 v52, v52
    v_rcp_f32 v53, v53
    v_rcp_f32 v54, v54
    v_rcp_f32 v55, v55
    v_rcp_f32 v56, v56
    v_rcp_f32 v57, v57
    v_rcp_f32 v58, v58
    v_rcp_f32 v59, v59
    v_rcp_f32 v60, v60
    v_rcp_f32 v61, v61
    v_rcp_f32 v62, v62
    v_rcp_f32 v63, v63
    v_mul_f32 v48, v112, v48
    v_mul_f32 v49, v113, v49
    v_mul_f32 v50, v114, v50
    v_mul_f32 v51, v115, v51
    v_mul_f32 v52, v116, v52
    v_mul_f32 v53, v117, v53
    v_mul_f32 v54, v118, v54
    v_mul_f32 v55, v119, v55
    v_mul_f32 v56, v120, v56
    v_mul_f32 v57, v121, v57
    v_mul_f32 v58, v122, v58
    v_mul_f32 v59, v123, v59
    v_mul_f32 v60, v124, v60
    v_mul_f32 v61, v125, v61
    v_mul_f32 v62, v126, v62
    v_mul_f32 v63, v127, v63
    v_cvt_pk_bf16_f32 v112, v48, v49
    v_cvt_pk_bf16_f32 v113, v50, v51
    v_cvt_pk_bf16_f32 v114, v52, v53
    v_cvt_pk_bf16_f32 v115, v54, v55
    v_cvt_pk_bf16_f32 v116, v56, v57
    v_cvt_pk_bf16_f32 v117, v58, v59
    v_cvt_pk_bf16_f32 v118, v60, v61
    v_cvt_pk_bf16_f32 v119, v62, v63
    s_mov_b32 s65, s24
    v_lshlrev_b32 v8, 4, v0
    v_lshrrev_b32 v2, 3, v0
    v_bfe_u32 v3, v0, 4, 1
    v_lshlrev_b32 v3, 2, v3
    v_and_b32 v4, 7, v0
    v_xor_b32 v3, v3, v4
    v_lshlrev_b32 v3, 4, v3
    v_lshl_add_u32 v9, v2, 10, v3
    s_lshr_b32 s24, s22, 1
    s_lshl_b32 s27, s24, 7
    v_add_u32 v9, s27, v9
    s_mul_i32 s30, s28, 6144
    s_add_u32 s30, s30, 131072
    v_bfe_u32 v2, v0, 2, 2
    v_lshrrev_b32 v3, 5, v0
    v_lshl_add_u32 v3, v3, 2, v2
    v_lshlrev_b32 v10, 7, v3
    v_lshrrev_b32 v2, 1, v2
    v_lshl_add_u32 v10, v2, 6, v10
    v_bfe_u32 v3, v0, 4, 1
    v_lshl_add_u32 v10, v3, 5, v10
    v_bfe_u32 v3, v0, 1, 1
    v_lshl_add_u32 v10, v3, 4, v10
    v_and_b32 v3, 1, v0
    v_lshl_add_u32 v10, v3, 3, v10
    v_add_u32 v10, s30, v10
    v_xor_b32 v11, 64, v10
    s_and_b32 s24, s22, 1
    s_lshl_b32 s24, s24, 1
    s_lshl_b32 s25, s21, 2
    s_add_u32 s24, s24, s25
    s_mul_i32 s25, s24, 112
    s_mul_i32 s26, s28, 28
    s_add_u32 s25, s25, s26
    s_lshl_b32 s31, s25, 10
    s_add_u32 s31, s31, 3145728
    s_lshl_b32 s25, s24, 5
    s_lshl_b32 s26, s28, 3
    s_add_u32 s25, s25, s26
    s_lshl_b32 s32, s25, 10
    s_add_u32 s32, s32, 10485760
    s_mul_i32 s33, s28, 458752
    s_lshl_b32 s34, s28, 17
    s_lshl_b32 s25, s24, 7
    s_add_u32 s29, s25, 2228224
    v_and_b32 v2, 31, v0
    v_lshlrev_b32 v14, 2, v2
    v_lshrrev_b32 v3, 1, v2
    v_min_u32 v3, 13, v3
    v_and_b32 v4, 1, v0
    v_lshlrev_b32 v4, 3, v4
    v_lshl_add_u32 v15, v3, 7, v4
    s_and_b32 s25, s22, 1
    s_lshl_b32 s25, s25, 2
    s_lshl_b32 s26, s21, 12
    s_add_u32 s25, s25, s26
    s_add_u32 s35, s25, 2293760
    v_mov_b32 v21, 163776
    s_mov_b32 s64, 2097152
L_lp17:
    ds_read_b32 v22, v21 offset:4
    s_waitcnt lgkmcnt(0)
    v_cmp_gt_u32 vcc, 4, v22
    s_nop 4
    s_cbranch_vccz L_lpx18
    s_sub_u32 s64, s64, 1
    s_cmp_eq_u32 s64, 0
    s_cbranch_scc1 L_lpx18
    s_sleep 3
    s_branch L_lp17
L_lpx18:
    s_mov_b32 s24, s65
    s_add_u32 s25, s24, 0
    buffer_store_dwordx4 v[64:67], v8, s[12:15], s25 offen sc1
    s_add_u32 s25, s24, 1024
    buffer_store_dwordx4 v[68:71], v8, s[12:15], s25 offen sc1
    s_add_u32 s25, s24, 114688
    buffer_store_dwordx4 v[80:83], v8, s[12:15], s25 offen sc1
    s_add_u32 s25, s24, 115712
    buffer_store_dwordx4 v[84:87], v8, s[12:15], s25 offen sc1
    s_add_u32 s25, s24, 2048
    buffer_store_dwordx4 v[96:99], v8, s[12:15], s25 offen sc1
    s_add_u32 s25, s24, 3072
    buffer_store_dwordx4 v[100:103], v8, s[12:15], s25 offen sc1
    s_add_u32 s25, s24, 116736
    buffer_store_dwordx4 v[112:115], v8, s[12:15], s25 offen sc1
    s_add_u32 s25, s24, 117760
    buffer_store_dwordx4 v[116:119], v8, s[12:15], s25 offen sc1
    s_add_u32 m0, s30, 0
    s_add_u32 s26, s33, 0
    buffer_load_dwordx4 v9, s[48:51], s26 offen lds
    s_add_u32 m0, s30, 1024
    s_add_u32 s26, s33, 8192
    buffer_load_dwordx4 v9, s[48:51], s26 offen lds
    s_add_u32 m0, s30, 2048
    s_add_u32 s26, s33, 16384
    buffer_load_dwordx4 v9, s[48:51], s26 offen lds
    s_add_u32 m0, s30, 3072
    s_add_u32 s26, s33, 24576
    buffer_load_dwordx4 v9, s[48:51], s26 offen lds
    s_add_u32 m0, s30, 4096
    s_add_u32 s26, s33, 32768
    buffer_load_dwordx4 v9, s[48:51], s26 offen lds
    s_add_u32 m0, s30, 5120
    s_add_u32 s26, s33, 40960
    buffer_load_dwordx4 v9, s[48:51], s26 offen lds
    s_waitcnt vmcnt(0)
    s_lshl_b32 s24, s21, 12
    s_lshl_b32 s25, s22, 7
    s_add_u32 s24, s24, s25
    s_lshl_b32 s25, s28, 2
    s_add_u32 s24, s24, s25
    s_add_u32 s24, s24, 2293760
    v_mov_b32 v2, 0
    v_mov_b32 v3, 1
    s_mov_b64 exec, 1
    buffer_store_dword v3, v2, s[12:15], s24 offen sc1
    s_mov_b64 exec, -1
    s_branch L_G2
.p2align 7
L_KV:
    s_lshl_b32 s25, s21, 12
    s_sub_u32 s24, s22, 14
    s_lshl_b32 s24, s24, 11
    s_add_u32 s24, s24, s25
    s_lshl_b32 s25, s28, 9
    s_add_u32 s24, s24, s25
    s_add_u32 s30, s24, 2293760
    s_sub_u32 s24, s22, 14
    s_lshl_b32 s29, s24, 2
    s_add_u32 s29, s29, s28
    s_lshl_b32 s24, s24, 6
    s_lshl_b32 s27, s21, 7
    s_add_u32 s27, s27, s24
    s_lshl_b32 s27, s27, 10
    v_lshlrev_b32 v14, 4, v0
    s_lshl_b32 s31, s28, 4
    v_lshlrev_b32 v16, 3, v0
    v_mov_b32 v20, 0
    v_mov_b32 v21, 0
    s_waitcnt lgkmcnt(0)
    buffer_store_dwordx2 v[20:21], v16, s[12:15], s30 offen sc1
    s_lshl_b32 s25, s31, 10
    s_add_u32 s26, s25, s27
    v_xor_b32 v18, 0, v14
    s_add_u32 m0, s25, 0
    s_add_u32 s24, s26, 0
    buffer_load_dwordx4 v18, s[4:7], s24 offen lds
    v_xor_b32 v19, 16, v14
    s_add_u32 m0, s25, 1024
    s_add_u32 s24, s26, 1024
    buffer_load_dwordx4 v19, s[4:7], s24 offen lds
    v_xor_b32 v18, 32, v14
    s_add_u32 m0, s25, 2048
    s_add_u32 s24, s26, 2048
    buffer_load_dwordx4 v18, s[4:7], s24 offen lds
    v_xor_b32 v19, 48, v14
    s_add_u32 m0, s25, 3072
    s_add_u32 s24, s26, 3072
    buffer_load_dwordx4 v19, s[4:7], s24 offen lds
    v_xor_b32 v18, 64, v14
    s_add_u32 m0, s25, 4096
    s_add_u32 s24, s26, 4096
    buffer_load_dwordx4 v18, s[4:7], s24 offen lds
    v_xor_b32 v19, 80, v14
    s_add_u32 m0, s25, 5120
    s_add_u32 s24, s26, 5120
    buffer_load_dwordx4 v19, s[4:7], s24 offen lds
    v_xor_b32 v18, 96, v14
    s_add_u32 m0, s25, 6144
    s_add_u32 s24, s26, 6144
    buffer_load_dwordx4 v18, s[4:7], s24 offen lds
    v_xor_b32 v19, 112, v14
    s_add_u32 m0, s25, 7168
    s_add_u32 s24, s26, 7168
    buffer_load_dwordx4 v19, s[4:7], s24 offen lds
    v_xor_b32 v18, 128, v14
    s_add_u32 m0, s25, 8192
    s_add_u32 s24, s26, 8192
    buffer_load_dwordx4 v18, s[4:7], s24 offen lds
    v_xor_b32 v19, 144, v14
    s_add_u32 m0, s25, 9216
    s_add_u32 s24, s26, 9216
    buffer_load_dwordx4 v19, s[4:7], s24 offen lds
    v_xor_b32 v18, 160, v14
    s_add_u32 m0, s25, 10240
    s_add_u32 s24, s26, 10240
    buffer_load_dwordx4 v18, s[4:7], s24 offen lds
    v_xor_b32 v19, 176, v14
    s_add_u32 m0, s25, 11264
    s_add_u32 s24, s26, 11264
    buffer_load_dwordx4 v19, s[4:7], s24 offen lds
    v_xor_b32 v18, 192, v14
    s_add_u32 m0, s25, 12288
    s_add_u32 s24, s26, 12288
    buffer_load_dwordx4 v18, s[4:7], s24 offen lds
    v_xor_b32 v19, 208, v14
    s_add_u32 m0, s25, 13312
    s_add_u32 s24, s26, 13312
    buffer_load_dwordx4 v19, s[4:7], s24 offen lds
    v_xor_b32 v18, 224, v14
    s_add_u32 m0, s25, 14336
    s_add_u32 s24, s26, 14336
    buffer_load_dwordx4 v18, s[4:7], s24 offen lds
    v_xor_b32 v19, 240, v14
    s_add_u32 m0, s25, 15360
    s_add_u32 s24, s26, 15360
    buffer_load_dwordx4 v19, s[4:7], s24 offen lds
    v_and_b32 v2, 15, v0
    v_lshrrev_b32 v4, 4, v0
    v_xor_b32 v3, v4, v2
    v_lshlrev_b32 v3, 4, v3
    v_lshl_add_u32 v8, v2, 10, v3
    s_lshl_b32 s24, s28, 14
    v_add_u32 v8, s24, v8
    v_xor_b32 v9, 64, v8
    v_xor_b32 v10, 128, v8
    v_xor_b32 v11, 192, v8
    v_lshrrev_b32 v3, 2, v2
    v_lshl_add_u32 v3, v4, 3, v3
    v_lshlrev_b32 v12, 5, v3
    v_and_b32 v3, 3, v0
    v_lshl_add_u32 v12, v3, 3, v12
    v_add_u32 v12, 129024, v12
    v_lshlrev_b32 v13, 4, v4
    v_add_u32 v13, 161920, v13
    s_sub_u32 s24, s22, 14
    s_lshl_b32 s24, s24, 2
    s_add_u32 s24, s24, s28
    s_lshl_b32 s25, s21, 3
    s_add_u32 s38, s24, s25
    s_lshr_b32 s25, s38, 1
    s_lshl_b32 s25, s25, 11
    s_add_u32 s36, s25, 2097152
    s_and_b32 s37, s38, 1
    v_lshrrev_b32 v3, 1, v4
    v_lshlrev_b32 v6, 9, v3
    v_lshl_add_u32 v6, v2, 4, v6
    v_and_b32 v5, 1, v4
    v_lshl_add_u32 v6, v5, 3, v6
    s_lshl_b32 s24, s37, 8
    v_add_u32 v6, s24, v6
    v_lshlrev_b32 v7, 2, v2
    s_lshl_b32 s38, s38, 6
    s_add_u32 s38, s38, 2228224
    v_mov_b32 v64, 0
    v_mov_b32 v65, 0
    v_mov_b32 v66, 0
    v_mov_b32 v67, 0
    v_mov_b32 v68, 0
    v_mov_b32 v69, 0
    v_mov_b32 v70, 0
    v_mov_b32 v71, 0
    v_mov_b32 v21, 162944
    v_mov_b32 v22, 1
    s_setprio 3
    s_waitcnt vmcnt(0)
    s_barrier
    s_mov_b32 s65, 4
    ds_read_b128 v[24:27], v8 offset:0
    ds_read_b64_tr_b16 v[28:29], v12 offset:0
    ds_read_b64_tr_b16 v[30:31], v12 offset:128
    ds_read_b128 v[32:35], v13 offset:0
    ds_read_b128 v[36:39], v9 offset:0
    ds_read_b64_tr_b16 v[40:41], v12 offset:1024
    ds_read_b64_tr_b16 v[42:43], v12 offset:1152
    ds_read_b128 v[44:47], v13 offset:64
    ds_read_b128 v[48:51], v10 offset:0
    ds_read_b64_tr_b16 v[52:53], v12 offset:2048
    ds_read_b64_tr_b16 v[54:55], v12 offset:2176
    ds_read_b128 v[56:59], v13 offset:128
L_kvg:
    s_waitcnt lgkmcnt(8)
    ds_read_b128 v[80:83], v11 offset:0
    ds_read_b64_tr_b16 v[84:85], v12 offset:3072
    ds_read_b64_tr_b16 v[86:87], v12 offset:3200
    ds_read_b128 v[88:91], v13 offset:192
    v_mfma_f32_16x16x32_bf16 v[64:67], v[28:31], v[24:27], v[64:67]
    v_mfma_f32_16x16x32_bf16 v[68:71], v[32:35], v[24:27], v[68:71]
    s_waitcnt lgkmcnt(8)
    ds_read_b128 v[24:27], v8 offset:256
    ds_read_b64_tr_b16 v[28:29], v12 offset:4096
    ds_read_b64_tr_b16 v[30:31], v12 offset:4224
    ds_read_b128 v[32:35], v13 offset:256
    v_mfma_f32_16x16x32_bf16 v[64:67], v[40:43], v[36:39], v[64:67]
    v_mfma_f32_16x16x32_bf16 v[68:71], v[44:47], v[36:39], v[68:71]
    s_waitcnt lgkmcnt(8)
    ds_read_b128 v[36:39], v9 offset:256
    ds_read_b64_tr_b16 v[40:41], v12 offset:5120
    ds_read_b64_tr_b16 v[42:43], v12 offset:5248
    ds_read_b128 v[44:47], v13 offset:320
    v_mfma_f32_16x16x32_bf16 v[64:67], v[52:55], v[48:51], v[64:67]
    v_mfma_f32_16x16x32_bf16 v[68:71], v[56:59], v[48:51], v[68:71]
    s_waitcnt lgkmcnt(8)
    ds_read_b128 v[48:51], v10 offset:256
    ds_read_b64_tr_b16 v[52:53], v12 offset:6144
    ds_read_b64_tr_b16 v[54:55], v12 offset:6272
    ds_read_b128 v[56:59], v13 offset:384
    v_mfma_f32_16x16x32_bf16 v[64:67], v[84:87], v[80:83], v[64:67]
    v_mfma_f32_16x16x32_bf16 v[68:71], v[88:91], v[80:83], v[68:71]
    v_add_u32 v8, 256, v8
    v_add_u32 v9, 256, v9
    v_add_u32 v10, 256, v10
    v_add_u32 v11, 256, v11
    v_add_u32 v12, 4096, v12
    v_add_u32 v13, 256, v13
    s_sub_u32 s65, s65, 1
    s_cmp_lg_u32 s65, 0
    s_cbranch_scc1 L_kvg
    s_waitcnt lgkmcnt(0)
    s_mov_b64 exec, 1
    ds_add_u32 v21, v22 offset:8
    s_mov_b64 exec, -1
    v_cvt_pk_bf16_f32 v24, v64, v65
    v_cvt_pk_bf16_f32 v25, v66, v67
    buffer_store_dwordx2 v[24:25], v6, s[12:15], s36 offen sc1
    v_mul_f32 v26, 0xbfb8aa3b, v68
    v_exp_f32 v26, v26
    s_nop 0
    v_add_f32 v26, 1.0, v26
    v_rcp_f32 v26, v26
    buffer_store_dword v26, v7, s[12:15], s38 offen sc1
    s_waitcnt vmcnt(0)
    s_mov_b64 exec, 1
    ds_add_rtn_u32 v23, v21, v22
    s_waitcnt lgkmcnt(0)
    v_readfirstlane_b32 s24, v23
    s_mov_b64 exec, -1
    s_nop 2
    s_cmp_eq_u32 s24, 7
    s_cbranch_scc0 L_kv_nosig
    s_mov_b32 s64, 2097152
L_lp19:
    ds_read_b32 v23, v21 offset:4
    s_waitcnt lgkmcnt(0)
    v_cmp_gt_u32 vcc, 8, v23
    s_nop 4
    s_cbranch_vccz L_lpx20
    s_sub_u32 s64, s64, 1
    s_cmp_eq_u32 s64, 0
    s_cbranch_scc1 L_lpx20
    s_sleep 1
    s_branch L_lp19
L_lpx20:
    s_sub_u32 s24, s22, 14
    s_lshl_b32 s25, s21, 1
    s_add_u32 s24, s24, s25
    s_lshl_b32 s24, s24, 2
    v_mov_b32 v23, 0
    s_mov_b64 exec, 1
    buffer_store_dword v22, v23, s[60:63], s24 offen sc1
    buffer_store_dword v22, v23, s[60:63], s24 offen offset:128 sc1
    s_mov_b64 exec, -1
L_kv_nosig:
    s_barrier
    v_lshlrev_b32 v8, 4, v0
    v_lshrrev_b32 v2, 3, v0
    v_bfe_u32 v3, v0, 4, 1
    v_lshlrev_b32 v3, 2, v3
    v_and_b32 v4, 7, v0
    v_xor_b32 v3, v3, v4
    v_lshlrev_b32 v3, 4, v3
    v_lshl_add_u32 v9, v2, 10, v3
    s_lshr_b32 s24, s22, 1
    s_lshl_b32 s27, s24, 7
    v_add_u32 v9, s27, v9
    s_mul_i32 s30, s28, 6144
    s_add_u32 s30, s30, 131072
    v_bfe_u32 v2, v0, 2, 2
    v_lshrrev_b32 v3, 5, v0
    v_lshl_add_u32 v3, v3, 2, v2
    v_lshlrev_b32 v10, 7, v3
    v_lshrrev_b32 v2, 1, v2
    v_lshl_add_u32 v10, v2, 6, v10
    v_bfe_u32 v3, v0, 4, 1
    v_lshl_add_u32 v10, v3, 5, v10
    v_bfe_u32 v3, v0, 1, 1
    v_lshl_add_u32 v10, v3, 4, v10
    v_and_b32 v3, 1, v0
    v_lshl_add_u32 v10, v3, 3, v10
    v_add_u32 v10, s30, v10
    v_xor_b32 v11, 64, v10
    s_and_b32 s24, s22, 1
    s_lshl_b32 s24, s24, 1
    s_lshl_b32 s25, s21, 2
    s_add_u32 s24, s24, s25
    s_mul_i32 s25, s24, 112
    s_mul_i32 s26, s28, 28
    s_add_u32 s25, s25, s26
    s_lshl_b32 s31, s25, 10
    s_add_u32 s31, s31, 3145728
    s_lshl_b32 s25, s24, 5
    s_lshl_b32 s26, s28, 3
    s_add_u32 s25, s25, s26
    s_lshl_b32 s32, s25, 10
    s_add_u32 s32, s32, 10485760
    s_mul_i32 s33, s28, 458752
    s_lshl_b32 s34, s28, 17
    s_lshl_b32 s25, s24, 7
    s_add_u32 s29, s25, 2228224
    v_and_b32 v2, 31, v0
    v_lshlrev_b32 v14, 2, v2
    v_lshrrev_b32 v3, 1, v2
    v_min_u32 v3, 13, v3
    v_and_b32 v4, 1, v0
    v_lshlrev_b32 v4, 3, v4
    v_lshl_add_u32 v15, v3, 7, v4
    s_and_b32 s25, s22, 1
    s_lshl_b32 s25, s25, 2
    s_lshl_b32 s26, s21, 12
    s_add_u32 s25, s25, s26
    s_add_u32 s35, s25, 2293760
    v_mov_b32 v21, 163776
    s_mov_b32 s64, 2097152
L_lp21:
    ds_read_b32 v22, v21 offset:4
    s_waitcnt lgkmcnt(0)
    v_cmp_gt_u32 vcc, 4, v22
    s_nop 4
    s_cbranch_vccz L_lpx22
    s_sub_u32 s64, s64, 1
    s_cmp_eq_u32 s64, 0
    s_cbranch_scc1 L_lpx22
    s_sleep 3
    s_branch L_lp21
L_lpx22:
    s_add_u32 m0, s30, 0
    s_add_u32 s26, s33, 0
    buffer_load_dwordx4 v9, s[48:51], s26 offen lds
    s_add_u32 m0, s30, 1024
    s_add_u32 s26, s33, 8192
    buffer_load_dwordx4 v9, s[48:51], s26 offen lds
    s_add_u32 m0, s30, 2048
    s_add_u32 s26, s33, 16384
    buffer_load_dwordx4 v9, s[48:51], s26 offen lds
    s_add_u32 m0, s30, 3072
    s_add_u32 s26, s33, 24576
    buffer_load_dwordx4 v9, s[48:51], s26 offen lds
    s_add_u32 m0, s30, 4096
    s_add_u32 s26, s33, 32768
    buffer_load_dwordx4 v9, s[48:51], s26 offen lds
    s_add_u32 m0, s30, 5120
    s_add_u32 s26, s33, 40960
    buffer_load_dwordx4 v9, s[48:51], s26 offen lds
.p2align 7
L_G2:
    s_mov_b32 s64, 524288
L_poll23:
    buffer_load_dword v3, v15, s[12:15], s35 offen sc1
    s_waitcnt vmcnt(0)
    v_cmp_ne_u32 vcc, 1, v3
    s_nop 4
    s_cbranch_vccz L_pollx24
    s_sub_u32 s64, s64, 1
    s_cmp_eq_u32 s64, 0
    s_cbranch_scc1 L_pollx24
    s_sleep 8
    s_branch L_poll23
L_pollx24:
    s_setprio 0
    buffer_load_dword v12, v14, s[12:15], s29 offen sc1
    buffer_load_dword v13, v14, s[12:15], s29 offen offset:128 sc1
    s_add_u32 s26, s31, 0
    buffer_load_dwordx4 v[96:99], v8, s[12:15], s26 offen sc1
    s_add_u32 s26, s31, 114688
    buffer_load_dwordx4 v[100:103], v8, s[12:15], s26 offen sc1
    s_add_u32 s26, s31, 1024
    buffer_load_dwordx4 v[104:107], v8, s[12:15], s26 offen sc1
    s_add_u32 s26, s31, 115712
    buffer_load_dwordx4 v[108:111], v8, s[12:15], s26 offen sc1
    s_add_u32 s26, s31, 2048
    buffer_load_dwordx4 v[112:115], v8, s[12:15], s26 offen sc1
    s_add_u32 s26, s31, 116736
    buffer_load_dwordx4 v[116:119], v8, s[12:15], s26 offen sc1
    s_waitcnt vmcnt(4)
    ds_read_b64_tr_b16 v[16:17], v10 offset:0
    ds_read_b64_tr_b16 v[18:19], v10 offset:1024
    ds_read_b64_tr_b16 v[20:21], v11 offset:0
    ds_read_b64_tr_b16 v[22:23], v11 offset:1024
    s_waitcnt vmcnt(2)
    ds_read_b64_tr_b16 v[24:25], v10 offset:2048
    ds_read_b64_tr_b16 v[26:27], v10 offset:3072
    ds_read_b64_tr_b16 v[28:29], v11 offset:2048
    ds_read_b64_tr_b16 v[30:31], v11 offset:3072
    s_waitcnt lgkmcnt(4)
    v_mfma_f32_32x32x16_bf16 v[32:47], v[16:19], v[96:99], 0
    v_mfma_f32_32x32x16_bf16 v[48:63], v[16:19], v[100:103], 0
    v_mfma_f32_32x32x16_bf16 v[64:79], v[20:23], v[96:99], 0
    v_mfma_f32_32x32x16_bf16 v[80:95], v[20:23], v[100:103], 0
    s_add_u32 m0, s30, 0
    s_add_u32 s26, s33, 49152
    buffer_load_dwordx4 v9, s[48:51], s26 offen lds
    s_add_u32 m0, s30, 1024
    s_add_u32 s26, s33, 57344
    buffer_load_dwordx4 v9, s[48:51], s26 offen lds
    s_add_u32 s26, s31, 3072
    buffer_load_dwordx4 v[96:99], v8, s[12:15], s26 offen sc1
    s_add_u32 s26, s31, 117760
    buffer_load_dwordx4 v[100:103], v8, s[12:15], s26 offen sc1
    s_waitcnt vmcnt(4)
    ds_read_b64_tr_b16 v[16:17], v10 offset:4096
    ds_read_b64_tr_b16 v[18:19], v10 offset:5120
    ds_read_b64_tr_b16 v[20:21], v11 offset:4096
    ds_read_b64_tr_b16 v[22:23], v11 offset:5120
    s_waitcnt lgkmcnt(4)
    v_mfma_f32_32x32x16_bf16 v[32:47], v[24:27], v[104:107], v[32:47]
    v_mfma_f32_32x32x16_bf16 v[48:63], v[24:27], v[108:111], v[48:63]
    v_mfma_f32_32x32x16_bf16 v[64:79], v[28:31], v[104:107], v[64:79]
    v_mfma_f32_32x32x16_bf16 v[80:95], v[28:31], v[108:111], v[80:95]
    s_add_u32 m0, s30, 2048
    s_add_u32 s26, s33, 65536
    buffer_load_dwordx4 v9, s[48:51], s26 offen lds
    s_add_u32 m0, s30, 3072
    s_add_u32 s26, s33, 73728
    buffer_load_dwordx4 v9, s[48:51], s26 offen lds
    s_add_u32 s26, s31, 4096
    buffer_load_dwordx4 v[104:107], v8, s[12:15], s26 offen sc1
    s_add_u32 s26, s31, 118784
    buffer_load_dwordx4 v[108:111], v8, s[12:15], s26 offen sc1
    s_waitcnt vmcnt(4)
    ds_read_b64_tr_b16 v[24:25], v10 offset:0
    ds_read_b64_tr_b16 v[26:27], v10 offset:1024
    ds_read_b64_tr_b16 v[28:29], v11 offset:0
    ds_read_b64_tr_b16 v[30:31], v11 offset:1024
    s_waitcnt lgkmcnt(4)
    v_mfma_f32_32x32x16_bf16 v[32:47], v[16:19], v[112:115], v[32:47]
    v_mfma_f32_32x32x16_bf16 v[48:63], v[16:19], v[116:119], v[48:63]
    v_mfma_f32_32x32x16_bf16 v[64:79], v[20:23], v[112:115], v[64:79]
    v_mfma_f32_32x32x16_bf16 v[80:95], v[20:23], v[116:119], v[80:95]
    s_add_u32 m0, s30, 4096
    s_add_u32 s26, s33, 81920
    buffer_load_dwordx4 v9, s[48:51], s26 offen lds
    s_add_u32 m0, s30, 5120
    s_add_u32 s26, s33, 90112
    buffer_load_dwordx4 v9, s[48:51], s26 offen lds
    s_add_u32 s26, s31, 5120
    buffer_load_dwordx4 v[112:115], v8, s[12:15], s26 offen sc1
    s_add_u32 s26, s31, 119808
    buffer_load_dwordx4 v[116:119], v8, s[12:15], s26 offen sc1
    s_waitcnt vmcnt(4)
    ds_read_b64_tr_b16 v[16:17], v10 offset:2048
    ds_read_b64_tr_b16 v[18:19], v10 offset:3072
    ds_read_b64_tr_b16 v[20:21], v11 offset:2048
    ds_read_b64_tr_b16 v[22:23], v11 offset:3072
    s_waitcnt lgkmcnt(4)
    v_mfma_f32_32x32x16_bf16 v[32:47], v[24:27], v[96:99], v[32:47]
    v_mfma_f32_32x32x16_bf16 v[48:63], v[24:27], v[100:103], v[48:63]
    v_mfma_f32_32x32x16_bf16 v[64:79], v[28:31], v[96:99], v[64:79]
    v_mfma_f32_32x32x16_bf16 v[80:95], v[28:31], v[100:103], v[80:95]
    s_add_u32 m0, s30, 0
    s_add_u32 s26, s33, 98304
    buffer_load_dwordx4 v9, s[48:51], s26 offen lds
    s_add_u32 m0, s30, 1024
    s_add_u32 s26, s33, 106496
    buffer_load_dwordx4 v9, s[48:51], s26 offen lds
    s_add_u32 s26, s31, 6144
    buffer_load_dwordx4 v[96:99], v8, s[12:15], s26 offen sc1
    s_add_u32 s26, s31, 120832
    buffer_load_dwordx4 v[100:103], v8, s[12:15], s26 offen sc1
    s_waitcnt vmcnt(4)
    ds_read_b64_tr_b16 v[24:25], v10 offset:4096
    ds_read_b64_tr_b16 v[26:27], v10 offset:5120
    ds_read_b64_tr_b16 v[28:29], v11 offset:4096
    ds_read_b64_tr_b16 v[30:31], v11 offset:5120
    s_waitcnt lgkmcnt(4)
    v_mfma_f32_32x32x16_bf16 v[32:47], v[16:19], v[104:107], v[32:47]
    v_mfma_f32_32x32x16_bf16 v[48:63], v[16:19], v[108:111], v[48:63]
    v_mfma_f32_32x32x16_bf16 v[64:79], v[20:23], v[104:107], v[64:79]
    v_mfma_f32_32x32x16_bf16 v[80:95], v[20:23], v[108:111], v[80:95]
    s_add_u32 m0, s30, 2048
    s_add_u32 s26, s33, 114688
    buffer_load_dwordx4 v9, s[48:51], s26 offen lds
    s_add_u32 m0, s30, 3072
    s_add_u32 s26, s33, 122880
    buffer_load_dwordx4 v9, s[48:51], s26 offen lds
    s_add_u32 s26, s31, 7168
    buffer_load_dwordx4 v[104:107], v8, s[12:15], s26 offen sc1
    s_add_u32 s26, s31, 121856
    buffer_load_dwordx4 v[108:111], v8, s[12:15], s26 offen sc1
    s_waitcnt vmcnt(4)
    ds_read_b64_tr_b16 v[16:17], v10 offset:0
    ds_read_b64_tr_b16 v[18:19], v10 offset:1024
    ds_read_b64_tr_b16 v[20:21], v11 offset:0
    ds_read_b64_tr_b16 v[22:23], v11 offset:1024
    s_waitcnt lgkmcnt(4)
    v_mfma_f32_32x32x16_bf16 v[32:47], v[24:27], v[112:115], v[32:47]
    v_mfma_f32_32x32x16_bf16 v[48:63], v[24:27], v[116:119], v[48:63]
    v_mfma_f32_32x32x16_bf16 v[64:79], v[28:31], v[112:115], v[64:79]
    v_mfma_f32_32x32x16_bf16 v[80:95], v[28:31], v[116:119], v[80:95]
    s_add_u32 m0, s30, 4096
    s_add_u32 s26, s33, 131072
    buffer_load_dwordx4 v9, s[48:51], s26 offen lds
    s_add_u32 m0, s30, 5120
    s_add_u32 s26, s33, 139264
    buffer_load_dwordx4 v9, s[48:51], s26 offen lds
    s_add_u32 s26, s31, 8192
    buffer_load_dwordx4 v[112:115], v8, s[12:15], s26 offen sc1
    s_add_u32 s26, s31, 122880
    buffer_load_dwordx4 v[116:119], v8, s[12:15], s26 offen sc1
    s_waitcnt vmcnt(4)
    ds_read_b64_tr_b16 v[24:25], v10 offset:2048
    ds_read_b64_tr_b16 v[26:27], v10 offset:3072
    ds_read_b64_tr_b16 v[28:29], v11 offset:2048
    ds_read_b64_tr_b16 v[30:31], v11 offset:3072
    s_waitcnt lgkmcnt(4)
    v_mfma_f32_32x32x16_bf16 v[32:47], v[16:19], v[96:99], v[32:47]
    v_mfma_f32_32x32x16_bf16 v[48:63], v[16:19], v[100:103], v[48:63]
    v_mfma_f32_32x32x16_bf16 v[64:79], v[20:23], v[96:99], v[64:79]
    v_mfma_f32_32x32x16_bf16 v[80:95], v[20:23], v[100:103], v[80:95]
    s_add_u32 m0, s30, 0
    s_add_u32 s26, s33, 147456
    buffer_load_dwordx4 v9, s[48:51], s26 offen lds
    s_add_u32 m0, s30, 1024
    s_add_u32 s26, s33, 155648
    buffer_load_dwordx4 v9, s[48:51], s26 offen lds
    s_add_u32 s26, s31, 9216
    buffer_load_dwordx4 v[96:99], v8, s[12:15], s26 offen sc1
    s_add_u32 s26, s31, 123904
    buffer_load_dwordx4 v[100:103], v8, s[12:15], s26 offen sc1
    s_waitcnt vmcnt(4)
    ds_read_b64_tr_b16 v[16:17], v10 offset:4096
    ds_read_b64_tr_b16 v[18:19], v10 offset:5120
    ds_read_b64_tr_b16 v[20:21], v11 offset:4096
    ds_read_b64_tr_b16 v[22:23], v11 offset:5120
    s_waitcnt lgkmcnt(4)
    v_mfma_f32_32x32x16_bf16 v[32:47], v[24:27], v[104:107], v[32:47]
    v_mfma_f32_32x32x16_bf16 v[48:63], v[24:27], v[108:111], v[48:63]
    v_mfma_f32_32x32x16_bf16 v[64:79], v[28:31], v[104:107], v[64:79]
    v_mfma_f32_32x32x16_bf16 v[80:95], v[28:31], v[108:111], v[80:95]
    s_add_u32 m0, s30, 2048
    s_add_u32 s26, s33, 163840
    buffer_load_dwordx4 v9, s[48:51], s26 offen lds
    s_add_u32 m0, s30, 3072
    s_add_u32 s26, s33, 172032
    buffer_load_dwordx4 v9, s[48:51], s26 offen lds
    s_add_u32 s26, s31, 10240
    buffer_load_dwordx4 v[104:107], v8, s[12:15], s26 offen sc1
    s_add_u32 s26, s31, 124928
    buffer_load_dwordx4 v[108:111], v8, s[12:15], s26 offen sc1
    s_waitcnt vmcnt(4)
    ds_read_b64_tr_b16 v[24:25], v10 offset:0
    ds_read_b64_tr_b16 v[26:27], v10 offset:1024
    ds_read_b64_tr_b16 v[28:29], v11 offset:0
    ds_read_b64_tr_b16 v[30:31], v11 offset:1024
    s_waitcnt lgkmcnt(4)
    v_mfma_f32_32x32x16_bf16 v[32:47], v[16:19], v[112:115], v[32:47]
    v_mfma_f32_32x32x16_bf16 v[48:63], v[16:19], v[116:119], v[48:63]
    v_mfma_f32_32x32x16_bf16 v[64:79], v[20:23], v[112:115], v[64:79]
    v_mfma_f32_32x32x16_bf16 v[80:95], v[20:23], v[116:119], v[80:95]
    s_add_u32 m0, s30, 4096
    s_add_u32 s26, s33, 180224
    buffer_load_dwordx4 v9, s[48:51], s26 offen lds
    s_add_u32 m0, s30, 5120
    s_add_u32 s26, s33, 188416
    buffer_load_dwordx4 v9, s[48:51], s26 offen lds
    s_add_u32 s26, s31, 11264
    buffer_load_dwordx4 v[112:115], v8, s[12:15], s26 offen sc1
    s_add_u32 s26, s31, 125952
    buffer_load_dwordx4 v[116:119], v8, s[12:15], s26 offen sc1
    s_waitcnt vmcnt(4)
    ds_read_b64_tr_b16 v[16:17], v10 offset:2048
    ds_read_b64_tr_b16 v[18:19], v10 offset:3072
    ds_read_b64_tr_b16 v[20:21], v11 offset:2048
    ds_read_b64_tr_b16 v[22:23], v11 offset:3072
    s_waitcnt lgkmcnt(4)
    v_mfma_f32_32x32x16_bf16 v[32:47], v[24:27], v[96:99], v[32:47]
    v_mfma_f32_32x32x16_bf16 v[48:63], v[24:27], v[100:103], v[48:63]
    v_mfma_f32_32x32x16_bf16 v[64:79], v[28:31], v[96:99], v[64:79]
    v_mfma_f32_32x32x16_bf16 v[80:95], v[28:31], v[100:103], v[80:95]
    s_add_u32 m0, s30, 0
    s_add_u32 s26, s33, 196608
    buffer_load_dwordx4 v9, s[48:51], s26 offen lds
    s_add_u32 m0, s30, 1024
    s_add_u32 s26, s33, 204800
    buffer_load_dwordx4 v9, s[48:51], s26 offen lds
    s_add_u32 s26, s31, 12288
    buffer_load_dwordx4 v[96:99], v8, s[12:15], s26 offen sc1
    s_add_u32 s26, s31, 126976
    buffer_load_dwordx4 v[100:103], v8, s[12:15], s26 offen sc1
    s_waitcnt vmcnt(4)
    ds_read_b64_tr_b16 v[24:25], v10 offset:4096
    ds_read_b64_tr_b16 v[26:27], v10 offset:5120
    ds_read_b64_tr_b16 v[28:29], v11 offset:4096
    ds_read_b64_tr_b16 v[30:31], v11 offset:5120
    s_waitcnt lgkmcnt(4)
    v_mfma_f32_32x32x16_bf16 v[32:47], v[16:19], v[104:107], v[32:47]
    v_mfma_f32_32x32x16_bf16 v[48:63], v[16:19], v[108:111], v[48:63]
    v_mfma_f32_32x32x16_bf16 v[64:79], v[20:23], v[104:107], v[64:79]
    v_mfma_f32_32x32x16_bf16 v[80:95], v[20:23], v[108:111], v[80:95]
    s_add_u32 m0, s30, 2048
    s_add_u32 s26, s33, 212992
    buffer_load_dwordx4 v9, s[48:51], s26 offen lds
    s_add_u32 m0, s30, 3072
    s_add_u32 s26, s33, 221184
    buffer_load_dwordx4 v9, s[48:51], s26 offen lds
    s_add_u32 s26, s31, 13312
    buffer_load_dwordx4 v[104:107], v8, s[12:15], s26 offen sc1
    s_add_u32 s26, s31, 128000
    buffer_load_dwordx4 v[108:111], v8, s[12:15], s26 offen sc1
    s_waitcnt vmcnt(4)
    ds_read_b64_tr_b16 v[16:17], v10 offset:0
    ds_read_b64_tr_b16 v[18:19], v10 offset:1024
    ds_read_b64_tr_b16 v[20:21], v11 offset:0
    ds_read_b64_tr_b16 v[22:23], v11 offset:1024
    s_waitcnt lgkmcnt(4)
    v_mfma_f32_32x32x16_bf16 v[32:47], v[24:27], v[112:115], v[32:47]
    v_mfma_f32_32x32x16_bf16 v[48:63], v[24:27], v[116:119], v[48:63]
    v_mfma_f32_32x32x16_bf16 v[64:79], v[28:31], v[112:115], v[64:79]
    v_mfma_f32_32x32x16_bf16 v[80:95], v[28:31], v[116:119], v[80:95]
    s_add_u32 m0, s30, 4096
    s_add_u32 s26, s33, 229376
    buffer_load_dwordx4 v9, s[48:51], s26 offen lds
    s_add_u32 m0, s30, 5120
    s_add_u32 s26, s33, 237568
    buffer_load_dwordx4 v9, s[48:51], s26 offen lds
    s_add_u32 s26, s31, 14336
    buffer_load_dwordx4 v[112:115], v8, s[12:15], s26 offen sc1
    s_add_u32 s26, s31, 129024
    buffer_load_dwordx4 v[116:119], v8, s[12:15], s26 offen sc1
    s_waitcnt vmcnt(4)
    ds_read_b64_tr_b16 v[24:25], v10 offset:2048
    ds_read_b64_tr_b16 v[26:27], v10 offset:3072
    ds_read_b64_tr_b16 v[28:29], v11 offset:2048
    ds_read_b64_tr_b16 v[30:31], v11 offset:3072
    s_waitcnt lgkmcnt(4)
    v_mfma_f32_32x32x16_bf16 v[32:47], v[16:19], v[96:99], v[32:47]
    v_mfma_f32_32x32x16_bf16 v[48:63], v[16:19], v[100:103], v[48:63]
    v_mfma_f32_32x32x16_bf16 v[64:79], v[20:23], v[96:99], v[64:79]
    v_mfma_f32_32x32x16_bf16 v[80:95], v[20:23], v[100:103], v[80:95]
    s_add_u32 m0, s30, 0
    s_add_u32 s26, s33, 245760
    buffer_load_dwordx4 v9, s[48:51], s26 offen lds
    s_add_u32 m0, s30, 1024
    s_add_u32 s26, s33, 253952
    buffer_load_dwordx4 v9, s[48:51], s26 offen lds
    s_add_u32 s26, s31, 15360
    buffer_load_dwordx4 v[96:99], v8, s[12:15], s26 offen sc1
    s_add_u32 s26, s31, 130048
    buffer_load_dwordx4 v[100:103], v8, s[12:15], s26 offen sc1
    s_waitcnt vmcnt(4)
    ds_read_b64_tr_b16 v[16:17], v10 offset:4096
    ds_read_b64_tr_b16 v[18:19], v10 offset:5120
    ds_read_b64_tr_b16 v[20:21], v11 offset:4096
    ds_read_b64_tr_b16 v[22:23], v11 offset:5120
    s_waitcnt lgkmcnt(4)
    v_mfma_f32_32x32x16_bf16 v[32:47], v[24:27], v[104:107], v[32:47]
    v_mfma_f32_32x32x16_bf16 v[48:63], v[24:27], v[108:111], v[48:63]
    v_mfma_f32_32x32x16_bf16 v[64:79], v[28:31], v[104:107], v[64:79]
    v_mfma_f32_32x32x16_bf16 v[80:95], v[28:31], v[108:111], v[80:95]
    s_add_u32 m0, s30, 2048
    s_add_u32 s26, s33, 262144
    buffer_load_dwordx4 v9, s[48:51], s26 offen lds
    s_add_u32 m0, s30, 3072
    s_add_u32 s26, s33, 270336
    buffer_load_dwordx4 v9, s[48:51], s26 offen lds
    s_add_u32 s26, s31, 16384
    buffer_load_dwordx4 v[104:107], v8, s[12:15], s26 offen sc1
    s_add_u32 s26, s31, 131072
    buffer_load_dwordx4 v[108:111], v8, s[12:15], s26 offen sc1
    s_waitcnt vmcnt(4)
    ds_read_b64_tr_b16 v[24:25], v10 offset:0
    ds_read_b64_tr_b16 v[26:27], v10 offset:1024
    ds_read_b64_tr_b16 v[28:29], v11 offset:0
    ds_read_b64_tr_b16 v[30:31], v11 offset:1024
    s_waitcnt lgkmcnt(4)
    v_mfma_f32_32x32x16_bf16 v[32:47], v[16:19], v[112:115], v[32:47]
    v_mfma_f32_32x32x16_bf16 v[48:63], v[16:19], v[116:119], v[48:63]
    v_mfma_f32_32x32x16_bf16 v[64:79], v[20:23], v[112:115], v[64:79]
    v_mfma_f32_32x32x16_bf16 v[80:95], v[20:23], v[116:119], v[80:95]
    s_add_u32 m0, s30, 4096
    s_add_u32 s26, s33, 278528
    buffer_load_dwordx4 v9, s[48:51], s26 offen lds
    s_add_u32 m0, s30, 5120
    s_add_u32 s26, s33, 286720
    buffer_load_dwordx4 v9, s[48:51], s26 offen lds
    s_add_u32 s26, s31, 17408
    buffer_load_dwordx4 v[112:115], v8, s[12:15], s26 offen sc1
    s_add_u32 s26, s31, 132096
    buffer_load_dwordx4 v[116:119], v8, s[12:15], s26 offen sc1
    s_waitcnt vmcnt(4)
    ds_read_b64_tr_b16 v[16:17], v10 offset:2048
    ds_read_b64_tr_b16 v[18:19], v10 offset:3072
    ds_read_b64_tr_b16 v[20:21], v11 offset:2048
    ds_read_b64_tr_b16 v[22:23], v11 offset:3072
    s_waitcnt lgkmcnt(4)
    v_mfma_f32_32x32x16_bf16 v[32:47], v[24:27], v[96:99], v[32:47]
    v_mfma_f32_32x32x16_bf16 v[48:63], v[24:27], v[100:103], v[48:63]
    v_mfma_f32_32x32x16_bf16 v[64:79], v[28:31], v[96:99], v[64:79]
    v_mfma_f32_32x32x16_bf16 v[80:95], v[28:31], v[100:103], v[80:95]
    s_add_u32 m0, s30, 0
    s_add_u32 s26, s33, 294912
    buffer_load_dwordx4 v9, s[48:51], s26 offen lds
    s_add_u32 m0, s30, 1024
    s_add_u32 s26, s33, 303104
    buffer_load_dwordx4 v9, s[48:51], s26 offen lds
    s_add_u32 s26, s31, 18432
    buffer_load_dwordx4 v[96:99], v8, s[12:15], s26 offen sc1
    s_add_u32 s26, s31, 133120
    buffer_load_dwordx4 v[100:103], v8, s[12:15], s26 offen sc1
    s_waitcnt vmcnt(4)
    ds_read_b64_tr_b16 v[24:25], v10 offset:4096
    ds_read_b64_tr_b16 v[26:27], v10 offset:5120
    ds_read_b64_tr_b16 v[28:29], v11 offset:4096
    ds_read_b64_tr_b16 v[30:31], v11 offset:5120
    s_waitcnt lgkmcnt(4)
    v_mfma_f32_32x32x16_bf16 v[32:47], v[16:19], v[104:107], v[32:47]
    v_mfma_f32_32x32x16_bf16 v[48:63], v[16:19], v[108:111], v[48:63]
    v_mfma_f32_32x32x16_bf16 v[64:79], v[20:23], v[104:107], v[64:79]
    v_mfma_f32_32x32x16_bf16 v[80:95], v[20:23], v[108:111], v[80:95]
    s_add_u32 m0, s30, 2048
    s_add_u32 s26, s33, 311296
    buffer_load_dwordx4 v9, s[48:51], s26 offen lds
    s_add_u32 m0, s30, 3072
    s_add_u32 s26, s33, 319488
    buffer_load_dwordx4 v9, s[48:51], s26 offen lds
    s_add_u32 s26, s31, 19456
    buffer_load_dwordx4 v[104:107], v8, s[12:15], s26 offen sc1
    s_add_u32 s26, s31, 134144
    buffer_load_dwordx4 v[108:111], v8, s[12:15], s26 offen sc1
    s_waitcnt vmcnt(4)
    ds_read_b64_tr_b16 v[16:17], v10 offset:0
    ds_read_b64_tr_b16 v[18:19], v10 offset:1024
    ds_read_b64_tr_b16 v[20:21], v11 offset:0
    ds_read_b64_tr_b16 v[22:23], v11 offset:1024
    s_waitcnt lgkmcnt(4)
    v_mfma_f32_32x32x16_bf16 v[32:47], v[24:27], v[112:115], v[32:47]
    v_mfma_f32_32x32x16_bf16 v[48:63], v[24:27], v[116:119], v[48:63]
    v_mfma_f32_32x32x16_bf16 v[64:79], v[28:31], v[112:115], v[64:79]
    v_mfma_f32_32x32x16_bf16 v[80:95], v[28:31], v[116:119], v[80:95]
    s_add_u32 m0, s30, 4096
    s_add_u32 s26, s33, 327680
    buffer_load_dwordx4 v9, s[48:51], s26 offen lds
    s_add_u32 m0, s30, 5120
    s_add_u32 s26, s33, 335872
    buffer_load_dwordx4 v9, s[48:51], s26 offen lds
    s_add_u32 s26, s31, 20480
    buffer_load_dwordx4 v[112:115], v8, s[12:15], s26 offen sc1
    s_add_u32 s26, s31, 135168
    buffer_load_dwordx4 v[116:119], v8, s[12:15], s26 offen sc1
    s_waitcnt vmcnt(4)
    ds_read_b64_tr_b16 v[24:25], v10 offset:2048
    ds_read_b64_tr_b16 v[26:27], v10 offset:3072
    ds_read_b64_tr_b16 v[28:29], v11 offset:2048
    ds_read_b64_tr_b16 v[30:31], v11 offset:3072
    s_waitcnt lgkmcnt(4)
    v_mfma_f32_32x32x16_bf16 v[32:47], v[16:19], v[96:99], v[32:47]
    v_mfma_f32_32x32x16_bf16 v[48:63], v[16:19], v[100:103], v[48:63]
    v_mfma_f32_32x32x16_bf16 v[64:79], v[20:23], v[96:99], v[64:79]
    v_mfma_f32_32x32x16_bf16 v[80:95], v[20:23], v[100:103], v[80:95]
    s_add_u32 m0, s30, 0
    s_add_u32 s26, s33, 344064
    buffer_load_dwordx4 v9, s[48:51], s26 offen lds
    s_add_u32 m0, s30, 1024
    s_add_u32 s26, s33, 352256
    buffer_load_dwordx4 v9, s[48:51], s26 offen lds
    s_add_u32 s26, s31, 21504
    buffer_load_dwordx4 v[96:99], v8, s[12:15], s26 offen sc1
    s_add_u32 s26, s31, 136192
    buffer_load_dwordx4 v[100:103], v8, s[12:15], s26 offen sc1
    s_waitcnt vmcnt(4)
    ds_read_b64_tr_b16 v[16:17], v10 offset:4096
    ds_read_b64_tr_b16 v[18:19], v10 offset:5120
    ds_read_b64_tr_b16 v[20:21], v11 offset:4096
    ds_read_b64_tr_b16 v[22:23], v11 offset:5120
    s_waitcnt lgkmcnt(4)
    v_mfma_f32_32x32x16_bf16 v[32:47], v[24:27], v[104:107], v[32:47]
    v_mfma_f32_32x32x16_bf16 v[48:63], v[24:27], v[108:111], v[48:63]
    v_mfma_f32_32x32x16_bf16 v[64:79], v[28:31], v[104:107], v[64:79]
    v_mfma_f32_32x32x16_bf16 v[80:95], v[28:31], v[108:111], v[80:95]
    s_add_u32 m0, s30, 2048
    s_add_u32 s26, s33, 360448
    buffer_load_dwordx4 v9, s[48:51], s26 offen lds
    s_add_u32 m0, s30, 3072
    s_add_u32 s26, s33, 368640
    buffer_load_dwordx4 v9, s[48:51], s26 offen lds
    s_add_u32 s26, s31, 22528
    buffer_load_dwordx4 v[104:107], v8, s[12:15], s26 offen sc1
    s_add_u32 s26, s31, 137216
    buffer_load_dwordx4 v[108:111], v8, s[12:15], s26 offen sc1
    s_waitcnt vmcnt(4)
    ds_read_b64_tr_b16 v[24:25], v10 offset:0
    ds_read_b64_tr_b16 v[26:27], v10 offset:1024
    ds_read_b64_tr_b16 v[28:29], v11 offset:0
    ds_read_b64_tr_b16 v[30:31], v11 offset:1024
    s_waitcnt lgkmcnt(4)
    v_mfma_f32_32x32x16_bf16 v[32:47], v[16:19], v[112:115], v[32:47]
    v_mfma_f32_32x32x16_bf16 v[48:63], v[16:19], v[116:119], v[48:63]
    v_mfma_f32_32x32x16_bf16 v[64:79], v[20:23], v[112:115], v[64:79]
    v_mfma_f32_32x32x16_bf16 v[80:95], v[20:23], v[116:119], v[80:95]
    s_add_u32 m0, s30, 4096
    s_add_u32 s26, s33, 376832
    buffer_load_dwordx4 v9, s[48:51], s26 offen lds
    s_add_u32 m0, s30, 5120
    s_add_u32 s26, s33, 385024
    buffer_load_dwordx4 v9, s[48:51], s26 offen lds
    s_add_u32 s26, s31, 23552
    buffer_load_dwordx4 v[112:115], v8, s[12:15], s26 offen sc1
    s_add_u32 s26, s31, 138240
    buffer_load_dwordx4 v[116:119], v8, s[12:15], s26 offen sc1
    s_waitcnt vmcnt(4)
    ds_read_b64_tr_b16 v[16:17], v10 offset:2048
    ds_read_b64_tr_b16 v[18:19], v10 offset:3072
    ds_read_b64_tr_b16 v[20:21], v11 offset:2048
    ds_read_b64_tr_b16 v[22:23], v11 offset:3072
    s_waitcnt lgkmcnt(4)
    v_mfma_f32_32x32x16_bf16 v[32:47], v[24:27], v[96:99], v[32:47]
    v_mfma_f32_32x32x16_bf16 v[48:63], v[24:27], v[100:103], v[48:63]
    v_mfma_f32_32x32x16_bf16 v[64:79], v[28:31], v[96:99], v[64:79]
    v_mfma_f32_32x32x16_bf16 v[80:95], v[28:31], v[100:103], v[80:95]
    s_add_u32 m0, s30, 0
    s_add_u32 s26, s33, 393216
    buffer_load_dwordx4 v9, s[48:51], s26 offen lds
    s_add_u32 m0, s30, 1024
    s_add_u32 s26, s33, 401408
    buffer_load_dwordx4 v9, s[48:51], s26 offen lds
    s_add_u32 s26, s31, 24576
    buffer_load_dwordx4 v[96:99], v8, s[12:15], s26 offen sc1
    s_add_u32 s26, s31, 139264
    buffer_load_dwordx4 v[100:103], v8, s[12:15], s26 offen sc1
    s_waitcnt vmcnt(4)
    ds_read_b64_tr_b16 v[24:25], v10 offset:4096
    ds_read_b64_tr_b16 v[26:27], v10 offset:5120
    ds_read_b64_tr_b16 v[28:29], v11 offset:4096
    ds_read_b64_tr_b16 v[30:31], v11 offset:5120
    s_waitcnt lgkmcnt(4)
    v_mfma_f32_32x32x16_bf16 v[32:47], v[16:19], v[104:107], v[32:47]
    v_mfma_f32_32x32x16_bf16 v[48:63], v[16:19], v[108:111], v[48:63]
    v_mfma_f32_32x32x16_bf16 v[64:79], v[20:23], v[104:107], v[64:79]
    v_mfma_f32_32x32x16_bf16 v[80:95], v[20:23], v[108:111], v[80:95]
    s_add_u32 m0, s30, 2048
    s_add_u32 s26, s33, 409600
    buffer_load_dwordx4 v9, s[48:51], s26 offen lds
    s_add_u32 m0, s30, 3072
    s_add_u32 s26, s33, 417792
    buffer_load_dwordx4 v9, s[48:51], s26 offen lds
    s_add_u32 s26, s31, 25600
    buffer_load_dwordx4 v[104:107], v8, s[12:15], s26 offen sc1
    s_add_u32 s26, s31, 140288
    buffer_load_dwordx4 v[108:111], v8, s[12:15], s26 offen sc1
    s_waitcnt vmcnt(4)
    ds_read_b64_tr_b16 v[16:17], v10 offset:0
    ds_read_b64_tr_b16 v[18:19], v10 offset:1024
    ds_read_b64_tr_b16 v[20:21], v11 offset:0
    ds_read_b64_tr_b16 v[22:23], v11 offset:1024
    s_waitcnt lgkmcnt(4)
    v_mfma_f32_32x32x16_bf16 v[32:47], v[24:27], v[112:115], v[32:47]
    v_mfma_f32_32x32x16_bf16 v[48:63], v[24:27], v[116:119], v[48:63]
    v_mfma_f32_32x32x16_bf16 v[64:79], v[28:31], v[112:115], v[64:79]
    v_mfma_f32_32x32x16_bf16 v[80:95], v[28:31], v[116:119], v[80:95]
    s_add_u32 m0, s30, 4096
    s_add_u32 s26, s33, 425984
    buffer_load_dwordx4 v9, s[48:51], s26 offen lds
    s_add_u32 m0, s30, 5120
    s_add_u32 s26, s33, 434176
    buffer_load_dwordx4 v9, s[48:51], s26 offen lds
    s_add_u32 s26, s31, 26624
    buffer_load_dwordx4 v[112:115], v8, s[12:15], s26 offen sc1
    s_add_u32 s26, s31, 141312
    buffer_load_dwordx4 v[116:119], v8, s[12:15], s26 offen sc1
    s_waitcnt vmcnt(4)
    ds_read_b64_tr_b16 v[24:25], v10 offset:2048
    ds_read_b64_tr_b16 v[26:27], v10 offset:3072
    ds_read_b64_tr_b16 v[28:29], v11 offset:2048
    ds_read_b64_tr_b16 v[30:31], v11 offset:3072
    s_waitcnt lgkmcnt(4)
    v_mfma_f32_32x32x16_bf16 v[32:47], v[16:19], v[96:99], v[32:47]
    v_mfma_f32_32x32x16_bf16 v[48:63], v[16:19], v[100:103], v[48:63]
    v_mfma_f32_32x32x16_bf16 v[64:79], v[20:23], v[96:99], v[64:79]
    v_mfma_f32_32x32x16_bf16 v[80:95], v[20:23], v[100:103], v[80:95]
    s_add_u32 m0, s30, 0
    s_add_u32 s26, s33, 442368
    buffer_load_dwordx4 v9, s[48:51], s26 offen lds
    s_add_u32 m0, s30, 1024
    s_add_u32 s26, s33, 450560
    buffer_load_dwordx4 v9, s[48:51], s26 offen lds
    s_add_u32 s26, s31, 27648
    buffer_load_dwordx4 v[96:99], v8, s[12:15], s26 offen sc1
    s_add_u32 s26, s31, 142336
    buffer_load_dwordx4 v[100:103], v8, s[12:15], s26 offen sc1
    s_waitcnt vmcnt(4)
    ds_read_b64_tr_b16 v[16:17], v10 offset:4096
    ds_read_b64_tr_b16 v[18:19], v10 offset:5120
    ds_read_b64_tr_b16 v[20:21], v11 offset:4096
    ds_read_b64_tr_b16 v[22:23], v11 offset:5120
    s_waitcnt lgkmcnt(4)
    v_mfma_f32_32x32x16_bf16 v[32:47], v[24:27], v[104:107], v[32:47]
    v_mfma_f32_32x32x16_bf16 v[48:63], v[24:27], v[108:111], v[48:63]
    v_mfma_f32_32x32x16_bf16 v[64:79], v[28:31], v[104:107], v[64:79]
    v_mfma_f32_32x32x16_bf16 v[80:95], v[28:31], v[108:111], v[80:95]
    s_waitcnt vmcnt(0)
    ds_read_b64_tr_b16 v[24:25], v10 offset:0
    ds_read_b64_tr_b16 v[26:27], v10 offset:1024
    ds_read_b64_tr_b16 v[28:29], v11 offset:0
    ds_read_b64_tr_b16 v[30:31], v11 offset:1024
    s_waitcnt lgkmcnt(4)
    v_mfma_f32_32x32x16_bf16 v[32:47], v[16:19], v[112:115], v[32:47]
    v_mfma_f32_32x32x16_bf16 v[48:63], v[16:19], v[116:119], v[48:63]
    v_mfma_f32_32x32x16_bf16 v[64:79], v[20:23], v[112:115], v[64:79]
    v_mfma_f32_32x32x16_bf16 v[80:95], v[20:23], v[116:119], v[80:95]
    s_waitcnt lgkmcnt(0)
    v_mfma_f32_32x32x16_bf16 v[32:47], v[24:27], v[96:99], v[32:47]
    v_mfma_f32_32x32x16_bf16 v[48:63], v[24:27], v[100:103], v[48:63]
    v_mfma_f32_32x32x16_bf16 v[64:79], v[28:31], v[96:99], v[64:79]
    v_mfma_f32_32x32x16_bf16 v[80:95], v[28:31], v[100:103], v[80:95]
    s_add_u32 m0, s30, 2048
    s_add_u32 s26, s34, 0
    buffer_load_dwordx4 v9, s[52:55], s26 offen lds
    s_add_u32 m0, s30, 3072
    s_add_u32 s26, s34, 8192
    buffer_load_dwordx4 v9, s[52:55], s26 offen lds
    s_add_u32 m0, s30, 4096
    s_add_u32 s26, s34, 16384
    buffer_load_dwordx4 v9, s[52:55], s26 offen lds
    s_add_u32 m0, s30, 5120
    s_add_u32 s26, s34, 24576
    buffer_load_dwordx4 v9, s[52:55], s26 offen lds
    s_add_u32 m0, s30, 0
    s_add_u32 s26, s34, 32768
    buffer_load_dwordx4 v9, s[52:55], s26 offen lds
    s_add_u32 m0, s30, 1024
    s_add_u32 s26, s34, 40960
    buffer_load_dwordx4 v9, s[52:55], s26 offen lds
    v_sub_f32 v2, 1.0, v12
    v_sub_f32 v3, 1.0, v13
    v_mul_f32 v32, v32, v2
    v_mul_f32 v33, v33, v2
    v_mul_f32 v34, v34, v2
    v_mul_f32 v35, v35, v2
    v_mul_f32 v36, v36, v2
    v_mul_f32 v37, v37, v2
    v_mul_f32 v38, v38, v2
    v_mul_f32 v39, v39, v2
    v_mul_f32 v40, v40, v2
    v_mul_f32 v41, v41, v2
    v_mul_f32 v42, v42, v2
    v_mul_f32 v43, v43, v2
    v_mul_f32 v44, v44, v2
    v_mul_f32 v45, v45, v2
    v_mul_f32 v46, v46, v2
    v_mul_f32 v47, v47, v2
    v_mul_f32 v48, v48, v3
    v_mul_f32 v49, v49, v3
    v_mul_f32 v50, v50, v3
    v_mul_f32 v51, v51, v3
    v_mul_f32 v52, v52, v3
    v_mul_f32 v53, v53, v3
    v_mul_f32 v54, v54, v3
    v_mul_f32 v55, v55, v3
    v_mul_f32 v56, v56, v3
    v_mul_f32 v57, v57, v3
    v_mul_f32 v58, v58, v3
    v_mul_f32 v59, v59, v3
    v_mul_f32 v60, v60, v3
    v_mul_f32 v61, v61, v3
    v_mul_f32 v62, v62, v3
    v_mul_f32 v63, v63, v3
    v_mul_f32 v64, v64, v2
    v_mul_f32 v65, v65, v2
    v_mul_f32 v66, v66, v2
    v_mul_f32 v67, v67, v2
    v_mul_f32 v68, v68, v2
    v_mul_f32 v69, v69, v2
    v_mul_f32 v70, v70, v2
    v_mul_f32 v71, v71, v2
    v_mul_f32 v72, v72, v2
    v_mul_f32 v73, v73, v2
    v_mul_f32 v74, v74, v2
    v_mul_f32 v75, v75, v2
    v_mul_f32 v76, v76, v2
    v_mul_f32 v77, v77, v2
    v_mul_f32 v78, v78, v2
    v_mul_f32 v79, v79, v2
    v_mul_f32 v80, v80, v3
    v_mul_f32 v81, v81, v3
    v_mul_f32 v82, v82, v3
    v_mul_f32 v83, v83, v3
    v_mul_f32 v84, v84, v3
    v_mul_f32 v85, v85, v3
    v_mul_f32 v86, v86, v3
    v_mul_f32 v87, v87, v3
    v_mul_f32 v88, v88, v3
    v_mul_f32 v89, v89, v3
    v_mul_f32 v90, v90, v3
    v_mul_f32 v91, v91, v3
    v_mul_f32 v92, v92, v3
    v_mul_f32 v93, v93, v3
    v_mul_f32 v94, v94, v3
    v_mul_f32 v95, v95, v3
    v_and_b32 v2, 31, v0
    v_lshrrev_b32 v3, 5, v0
    v_and_b32 v4, 15, v0
    v_xor_b32 v3, v3, v4
    v_lshlrev_b32 v3, 4, v3
    v_lshl_add_u32 v2, v2, 8, v3
    s_lshl_b32 s24, s28, 14
    v_add_u32 v2, s24, v2
    v_xor_b32 v160, 0, v2
    v_xor_b32 v161, 32, v2
    v_xor_b32 v162, 64, v2
    v_xor_b32 v163, 96, v2
    v_xor_b32 v164, 128, v2
    v_xor_b32 v165, 160, v2
    v_xor_b32 v166, 192, v2
    v_xor_b32 v167, 224, v2
    v_lshrrev_b32 v2, 3, v0
    v_and_b32 v3, 7, v0
    v_lshlrev_b32 v3, 1, v3
    s_lshl_b32 s24, s28, 4
    v_add_u32 v4, 0, v2
    v_xor_b32 v5, v3, v4
    v_lshlrev_b32 v5, 4, v5
    v_add_u32 v4, s24, v4
    v_lshl_add_u32 v12, v4, 8, v5
    v_xor_b32 v14, 16, v12
    v_add_u32 v4, 8, v2
    v_xor_b32 v5, v3, v4
    v_lshlrev_b32 v5, 4, v5
    v_add_u32 v4, s24, v4
    v_lshl_add_u32 v13, v4, 8, v5
    v_xor_b32 v15, 16, v13
    s_and_b32 s25, s22, 1
    s_lshl_b32 s25, s25, 6
    s_lshl_b32 s26, s21, 7
    s_add_u32 s25, s25, s26
    s_add_u32 s25, s25, s24
    v_add_u32 v4, s25, v2
    v_lshlrev_b32 v4, 10, v4
    v_and_b32 v3, 7, v0
    v_lshl_add_u32 v5, v3, 4, v4
    s_lshr_b32 s39, s22, 1
    s_lshl_b32 s39, s39, 7
    s_waitcnt vmcnt(0)
    ds_read_b64_tr_b16 v[16:17], v10 offset:2048
    ds_read_b64_tr_b16 v[18:19], v10 offset:3072
    ds_read_b64_tr_b16 v[20:21], v11 offset:2048
    ds_read_b64_tr_b16 v[22:23], v11 offset:3072
    ds_read_b64_tr_b16 v[24:25], v10 offset:4096
    ds_read_b64_tr_b16 v[26:27], v10 offset:5120
    ds_read_b64_tr_b16 v[28:29], v11 offset:4096
    ds_read_b64_tr_b16 v[30:31], v11 offset:5120
    v_add_u32 v6, 0xffff0000, v10
    v_add_u32 v7, 0xffff0000, v11
    s_waitcnt lgkmcnt(0)
    s_add_u32 m0, s30, 2048
    s_add_u32 s26, s34, 49152
    buffer_load_dwordx4 v9, s[52:55], s26 offen lds
    s_add_u32 m0, s30, 3072
    s_add_u32 s26, s34, 57344
    buffer_load_dwordx4 v9, s[52:55], s26 offen lds
    s_add_u32 m0, s30, 4096
    s_add_u32 s26, s34, 65536
    buffer_load_dwordx4 v9, s[52:55], s26 offen lds
    s_add_u32 m0, s30, 5120
    s_add_u32 s26, s34, 73728
    buffer_load_dwordx4 v9, s[52:55], s26 offen lds
    v_mov_b32 v2, 163776
    s_setprio 3
    s_mov_b32 s64, 2097152
L_lp25:
    ds_read_b32 v3, v2 offset:16
    s_waitcnt lgkmcnt(0)
    v_cmp_gt_u32 vcc, 8, v3
    s_nop 4
    s_cbranch_vccz L_lpx26
    s_sub_u32 s64, s64, 1
    s_cmp_eq_u32 s64, 0
    s_cbranch_scc1 L_lpx26
    s_sleep 2
    s_branch L_lp25
L_lpx26:
    s_mov_b32 s64, 262144
    s_add_u32 m0, s30, 0xffff0000
    s_add_u32 s26, s34, 81920
    buffer_load_dwordx4 v9, s[52:55], s26 offen lds
    s_add_u32 m0, s30, 0xffff0400
    s_add_u32 s26, s34, 90112
    buffer_load_dwordx4 v9, s[52:55], s26 offen lds
    s_add_u32 m0, s30, 0xffff0800
    s_add_u32 s26, s34, 98304
    buffer_load_dwordx4 v9, s[52:55], s26 offen lds
    s_add_u32 m0, s30, 0xffff0c00
    s_add_u32 s26, s34, 106496
    buffer_load_dwordx4 v9, s[52:55], s26 offen lds
    s_add_u32 m0, s30, 0xffff1000
    s_add_u32 s26, s34, 114688
    buffer_load_dwordx4 v9, s[52:55], s26 offen lds
    s_add_u32 m0, s30, 0xffff1400
    s_add_u32 s26, s34, 122880
    buffer_load_dwordx4 v9, s[52:55], s26 offen lds
L_of27:
    s_add_u32 s26, s32, 0
    buffer_load_dwordx4 v[96:99], v8, s[12:15], s26 offen sc1
    s_add_u32 s26, s32, 32768
    buffer_load_dwordx4 v[100:103], v8, s[12:15], s26 offen sc1
    s_add_u32 s26, s32, 1024
    buffer_load_dwordx4 v[104:107], v8, s[12:15], s26 offen sc1
    s_add_u32 s26, s32, 33792
    buffer_load_dwordx4 v[108:111], v8, s[12:15], s26 offen sc1
    s_add_u32 s26, s32, 2048
    buffer_load_dwordx4 v[112:115], v8, s[12:15], s26 offen sc1
    s_add_u32 s26, s32, 34816
    buffer_load_dwordx4 v[116:119], v8, s[12:15], s26 offen sc1
    s_add_u32 s26, s32, 3072
    buffer_load_dwordx4 v[120:123], v8, s[12:15], s26 offen sc1
    s_add_u32 s26, s32, 35840
    buffer_load_dwordx4 v[124:127], v8, s[12:15], s26 offen sc1
    s_add_u32 s26, s32, 4096
    buffer_load_dwordx4 v[128:131], v8, s[12:15], s26 offen sc1
    s_add_u32 s26, s32, 36864
    buffer_load_dwordx4 v[132:135], v8, s[12:15], s26 offen sc1
    s_add_u32 s26, s32, 5120
    buffer_load_dwordx4 v[136:139], v8, s[12:15], s26 offen sc1
    s_add_u32 s26, s32, 37888
    buffer_load_dwordx4 v[140:143], v8, s[12:15], s26 offen sc1
    s_add_u32 s26, s32, 6144
    buffer_load_dwordx4 v[144:147], v8, s[12:15], s26 offen sc1
    s_add_u32 s26, s32, 38912
    buffer_load_dwordx4 v[148:151], v8, s[12:15], s26 offen sc1
    s_add_u32 s26, s32, 7168
    buffer_load_dwordx4 v[152:155], v8, s[12:15], s26 offen sc1
    s_add_u32 s26, s32, 39936
    buffer_load_dwordx4 v[156:159], v8, s[12:15], s26 offen sc1
    s_waitcnt vmcnt(8)
    v_max3_u32 v2, v96, v97, v98
    v_max3_u32 v2, v2, v99, v100
    v_max3_u32 v2, v2, v101, v102
    v_max3_u32 v2, v2, v103, v104
    v_max3_u32 v2, v2, v105, v106
    v_max3_u32 v2, v2, v107, v108
    v_max3_u32 v2, v2, v109, v110
    v_max3_u32 v2, v2, v111, v112
    v_max3_u32 v2, v2, v113, v114
    v_max3_u32 v2, v2, v115, v116
    v_max3_u32 v2, v2, v117, v118
    v_max3_u32 v2, v2, v119, v120
    v_max3_u32 v2, v2, v121, v122
    v_max3_u32 v2, v2, v123, v124
    v_max3_u32 v2, v2, v125, v126
    v_max_u32 v2, v2, v127
    s_waitcnt vmcnt(0)
    v_max3_u32 v2, v2, v128, v129
    v_max3_u32 v2, v2, v130, v131
    v_max3_u32 v2, v2, v132, v133
    v_max3_u32 v2, v2, v134, v135
    v_max3_u32 v2, v2, v136, v137
    v_max3_u32 v2, v2, v138, v139
    v_max3_u32 v2, v2, v140, v141
    v_max3_u32 v2, v2, v142, v143
    v_max3_u32 v2, v2, v144, v145
    v_max3_u32 v2, v2, v146, v147
    v_max3_u32 v2, v2, v148, v149
    v_max3_u32 v2, v2, v150, v151
    v_max3_u32 v2, v2, v152, v153
    v_max3_u32 v2, v2, v154, v155
    v_max3_u32 v2, v2, v156, v157
    v_max3_u32 v2, v2, v158, v159
    v_cmp_eq_u32 vcc, -1, v2
    s_nop 4
    s_cbranch_vccz L_ofx28
    s_sub_u32 s64, s64, 1
    s_cmp_eq_u32 s64, 0
    s_cbranch_scc0 L_of27
L_ofx28:
    v_mfma_f32_32x32x16_bf16 v[32:47], v[16:19], v[96:99], v[32:47]
    v_mfma_f32_32x32x16_bf16 v[48:63], v[16:19], v[100:103], v[48:63]
    v_mfma_f32_32x32x16_bf16 v[64:79], v[20:23], v[96:99], v[64:79]
    v_mfma_f32_32x32x16_bf16 v[80:95], v[20:23], v[100:103], v[80:95]
    ds_read_b64_tr_b16 v[16:17], v10 offset:0
    ds_read_b64_tr_b16 v[18:19], v10 offset:1024
    ds_read_b64_tr_b16 v[20:21], v11 offset:0
    ds_read_b64_tr_b16 v[22:23], v11 offset:1024
    v_mfma_f32_32x32x16_bf16 v[32:47], v[24:27], v[104:107], v[32:47]
    v_mfma_f32_32x32x16_bf16 v[48:63], v[24:27], v[108:111], v[48:63]
    v_mfma_f32_32x32x16_bf16 v[64:79], v[28:31], v[104:107], v[64:79]
    v_mfma_f32_32x32x16_bf16 v[80:95], v[28:31], v[108:111], v[80:95]
    ds_read_b64_tr_b16 v[24:25], v10 offset:2048
    ds_read_b64_tr_b16 v[26:27], v10 offset:3072
    ds_read_b64_tr_b16 v[28:29], v11 offset:2048
    ds_read_b64_tr_b16 v[30:31], v11 offset:3072
    s_waitcnt lgkmcnt(4)
    v_mfma_f32_32x32x16_bf16 v[32:47], v[16:19], v[112:115], v[32:47]
    v_mfma_f32_32x32x16_bf16 v[48:63], v[16:19], v[116:119], v[48:63]
    v_mfma_f32_32x32x16_bf16 v[64:79], v[20:23], v[112:115], v[64:79]
    v_mfma_f32_32x32x16_bf16 v[80:95], v[20:23], v[116:119], v[80:95]
    ds_read_b64_tr_b16 v[16:17], v10 offset:4096
    ds_read_b64_tr_b16 v[18:19], v10 offset:5120
    ds_read_b64_tr_b16 v[20:21], v11 offset:4096
    ds_read_b64_tr_b16 v[22:23], v11 offset:5120
    s_waitcnt lgkmcnt(4)
    v_mfma_f32_32x32x16_bf16 v[32:47], v[24:27], v[120:123], v[32:47]
    v_mfma_f32_32x32x16_bf16 v[48:63], v[24:27], v[124:127], v[48:63]
    v_mfma_f32_32x32x16_bf16 v[64:79], v[28:31], v[120:123], v[64:79]
    v_mfma_f32_32x32x16_bf16 v[80:95], v[28:31], v[124:127], v[80:95]
    s_waitcnt vmcnt(0)
    ds_read_b64_tr_b16 v[24:25], v6 offset:0
    ds_read_b64_tr_b16 v[26:27], v6 offset:1024
    ds_read_b64_tr_b16 v[28:29], v7 offset:0
    ds_read_b64_tr_b16 v[30:31], v7 offset:1024
    s_waitcnt lgkmcnt(4)
    v_mfma_f32_32x32x16_bf16 v[32:47], v[16:19], v[128:131], v[32:47]
    v_mfma_f32_32x32x16_bf16 v[48:63], v[16:19], v[132:135], v[48:63]
    v_mfma_f32_32x32x16_bf16 v[64:79], v[20:23], v[128:131], v[64:79]
    v_mfma_f32_32x32x16_bf16 v[80:95], v[20:23], v[132:135], v[80:95]
    ds_read_b64_tr_b16 v[16:17], v6 offset:2048
    ds_read_b64_tr_b16 v[18:19], v6 offset:3072
    ds_read_b64_tr_b16 v[20:21], v7 offset:2048
    ds_read_b64_tr_b16 v[22:23], v7 offset:3072
    s_waitcnt lgkmcnt(4)
    v_mfma_f32_32x32x16_bf16 v[32:47], v[24:27], v[136:139], v[32:47]
    v_mfma_f32_32x32x16_bf16 v[48:63], v[24:27], v[140:143], v[48:63]
    v_mfma_f32_32x32x16_bf16 v[64:79], v[28:31], v[136:139], v[64:79]
    v_mfma_f32_32x32x16_bf16 v[80:95], v[28:31], v[140:143], v[80:95]
    ds_read_b64_tr_b16 v[24:25], v6 offset:4096
    ds_read_b64_tr_b16 v[26:27], v6 offset:5120
    ds_read_b64_tr_b16 v[28:29], v7 offset:4096
    ds_read_b64_tr_b16 v[30:31], v7 offset:5120
    s_waitcnt lgkmcnt(4)
    v_mfma_f32_32x32x16_bf16 v[32:47], v[16:19], v[144:147], v[32:47]
    v_mfma_f32_32x32x16_bf16 v[48:63], v[16:19], v[148:151], v[48:63]
    v_mfma_f32_32x32x16_bf16 v[64:79], v[20:23], v[144:147], v[64:79]
    v_mfma_f32_32x32x16_bf16 v[80:95], v[20:23], v[148:151], v[80:95]
    s_waitcnt lgkmcnt(0)
    v_mfma_f32_32x32x16_bf16 v[32:47], v[24:27], v[152:155], v[32:47]
    v_mfma_f32_32x32x16_bf16 v[48:63], v[24:27], v[156:159], v[48:63]
    v_mfma_f32_32x32x16_bf16 v[64:79], v[28:31], v[152:155], v[64:79]
    v_mfma_f32_32x32x16_bf16 v[80:95], v[28:31], v[156:159], v[80:95]
    s_nop 8
    ds_write_b128 v160, v[32:35] offset:0
    ds_write_b128 v161, v[36:39] offset:0
    ds_write_b128 v162, v[40:43] offset:0
    ds_write_b128 v163, v[44:47] offset:0
    ds_write_b128 v160, v[48:51] offset:8192
    ds_write_b128 v161, v[52:55] offset:8192
    ds_write_b128 v162, v[56:59] offset:8192
    ds_write_b128 v163, v[60:63] offset:8192
    ds_write_b128 v164, v[64:67] offset:0
    ds_write_b128 v165, v[68:71] offset:0
    ds_write_b128 v166, v[72:75] offset:0
    ds_write_b128 v167, v[76:79] offset:0
    ds_write_b128 v164, v[80:83] offset:8192
    ds_write_b128 v165, v[84:87] offset:8192
    ds_write_b128 v166, v[88:91] offset:8192
    ds_write_b128 v167, v[92:95] offset:8192
    s_waitcnt lgkmcnt(0)
    s_barrier
    ds_read_b128 v[96:99], v12 offset:0
    ds_read_b128 v[100:103], v14 offset:0
    ds_read_b128 v[104:107], v12 offset:16384
    ds_read_b128 v[108:111], v14 offset:16384
    ds_read_b128 v[112:115], v12 offset:32768
    ds_read_b128 v[116:119], v14 offset:32768
    ds_read_b128 v[120:123], v12 offset:49152
    ds_read_b128 v[124:127], v14 offset:49152
    ds_read_b128 v[128:131], v13 offset:0
    ds_read_b128 v[132:135], v15 offset:0
    ds_read_b128 v[136:139], v13 offset:16384
    ds_read_b128 v[140:143], v15 offset:16384
    ds_read_b128 v[144:147], v13 offset:32768
    ds_read_b128 v[148:151], v15 offset:32768
    ds_read_b128 v[152:155], v13 offset:49152
    ds_read_b128 v[156:159], v15 offset:49152
    s_waitcnt lgkmcnt(8)
    v_add_f32 v96, v96, v104
    v_add_f32 v112, v112, v120
    v_add_f32 v97, v97, v105
    v_add_f32 v113, v113, v121
    v_add_f32 v98, v98, v106
    v_add_f32 v114, v114, v122
    v_add_f32 v99, v99, v107
    v_add_f32 v115, v115, v123
    v_add_f32 v100, v100, v108
    v_add_f32 v116, v116, v124
    v_add_f32 v101, v101, v109
    v_add_f32 v117, v117, v125
    v_add_f32 v102, v102, v110
    v_add_f32 v118, v118, v126
    v_add_f32 v103, v103, v111
    v_add_f32 v119, v119, v127
    v_add_f32 v96, v96, v112
    v_add_f32 v97, v97, v113
    v_add_f32 v98, v98, v114
    v_add_f32 v99, v99, v115
    v_add_f32 v100, v100, v116
    v_add_f32 v101, v101, v117
    v_add_f32 v102, v102, v118
    v_add_f32 v103, v103, v119
    v_cvt_pk_bf16_f32 v16, v96, v97
    v_cvt_pk_bf16_f32 v17, v98, v99
    v_cvt_pk_bf16_f32 v18, v100, v101
    v_cvt_pk_bf16_f32 v19, v102, v103
    s_add_u32 s26, s39, 0
    buffer_store_dwordx4 v[16:19], v5, s[56:59], s26 offen
    s_waitcnt lgkmcnt(0)
    v_add_f32 v128, v128, v136
    v_add_f32 v144, v144, v152
    v_add_f32 v129, v129, v137
    v_add_f32 v145, v145, v153
    v_add_f32 v130, v130, v138
    v_add_f32 v146, v146, v154
    v_add_f32 v131, v131, v139
    v_add_f32 v147, v147, v155
    v_add_f32 v132, v132, v140
    v_add_f32 v148, v148, v156
    v_add_f32 v133, v133, v141
    v_add_f32 v149, v149, v157
    v_add_f32 v134, v134, v142
    v_add_f32 v150, v150, v158
    v_add_f32 v135, v135, v143
    v_add_f32 v151, v151, v159
    v_add_f32 v128, v128, v144
    v_add_f32 v129, v129, v145
    v_add_f32 v130, v130, v146
    v_add_f32 v131, v131, v147
    v_add_f32 v132, v132, v148
    v_add_f32 v133, v133, v149
    v_add_f32 v134, v134, v150
    v_add_f32 v135, v135, v151
    v_cvt_pk_bf16_f32 v20, v128, v129
    v_cvt_pk_bf16_f32 v21, v130, v131
    v_cvt_pk_bf16_f32 v22, v132, v133
    v_cvt_pk_bf16_f32 v23, v134, v135
    s_add_u32 s26, s39, 8192
    buffer_store_dwordx4 v[20:23], v5, s[56:59], s26 offen
L_exit:
    s_endpgm
L_code_end:
.section .rodata,"a"
.p2align 6
.amdhsa_kernel gated_mix__grouped_kv_mqa__dense_activation_silu__prompt_kernel
  .amdhsa_next_free_vgpr 168
  .amdhsa_next_free_sgpr 102
  .amdhsa_accum_offset 168
  .amdhsa_group_segment_fixed_size 0
  .amdhsa_kernarg_size 96
  .amdhsa_user_sgpr_count 2
  .amdhsa_user_sgpr_kernarg_segment_ptr 1
  .amdhsa_system_sgpr_workgroup_id_x 1
  .amdhsa_float_denorm_mode_32 3
.end_amdhsa_kernel
```
